```python
import torch

def _softmax(x, axis=-1):
    return torch.softmax(x, dim=axis)
def _gelu(x):
    return torch.nn.functional.gelu(x, approximate="tanh")
def _silu(x):
    return torch.nn.functional.silu(x)
def _sigmoid(x):
    return torch.sigmoid(x)
def _layernorm(x, axis=-1, eps=1e-5):
    m = x.mean(dim=axis, keepdim=True)
    v = x.var(dim=axis, keepdim=True, unbiased=False)
    return (x - m) / torch.sqrt(v + eps)
def _scatter_add(tgt, idx, src, axis=0):
    return tgt.clone().index_add_(axis, idx, src)
def _segment_sum(src, seg, n):
    out = torch.zeros((n,) + src.shape[1:], dtype=src.dtype)
    return out.index_add_(0, seg, src)
def _pad(x, pw):
    flat = tuple(v for pair in reversed(pw) for v in pair)
    return torch.nn.functional.pad(x, flat)

kernel_name = 'sequential_preLN__gqa_block_cached__geglu_ffn__decode'

def setup_inputs():

    _w = (lambda a: (lambda t: t.to(torch.bfloat16) if t.is_floating_point() else t)(torch.as_tensor(a)))
    def _A_setup():
        B, Sq, D = 1, 1, 1024
        Hq, Hkv, Sk, Dh = 32, 4, 65536, 128
        assert Hq % Hkv == 0, (Hq, Hkv)
        return {
            "x": _w((lambda *s: torch.randn(*s, dtype=torch.bfloat16) * 0.05)(B, Sq, D)),
            "k_cache": _w((lambda *s: torch.randn(*s, dtype=torch.bfloat16) * 3.2)(B, Hkv, Sk, Dh)),
            "v_cache": _w((lambda *s: torch.randn(*s, dtype=torch.bfloat16) * 0.4)(B, Hkv, Sk, Dh)),
            "wq": _w((lambda *s: torch.randn(*s, dtype=torch.bfloat16) * 3.2)(D, Hq * Dh) * (D ** -0.5)),
            "wo": _w((lambda *s: torch.randn(*s, dtype=torch.bfloat16) * 0.4)(Hq * Dh, D) * ((Hq * Dh) ** -0.5)),
        }
    _A_in = _A_setup()

    def _B_setup():
        B, S, D, F = 1, 1, 1024, 3584
        return {
            "x": _w((lambda *s: torch.randn(*s, dtype=torch.bfloat16) * 0.05)(B, S, D)),
            "w_gate": _w((lambda *s: torch.randn(*s, dtype=torch.bfloat16) * 0.05)(D, F)),
            "w_up": _w((lambda *s: torch.randn(*s, dtype=torch.bfloat16) * 0.05)(D, F)),
            "w_down": _w((lambda *s: torch.randn(*s, dtype=torch.bfloat16) * 0.05)(F, D)),
        }
    _B_in = _B_setup()

    return {
        "A_x": _A_in["x"],
        "A_k_cache": _A_in["k_cache"],
        "A_v_cache": _A_in["v_cache"],
        "A_wq": _A_in["wq"],
        "A_wo": _A_in["wo"],
        "B_x": _B_in["x"],
        "B_w_gate": _B_in["w_gate"],
        "B_w_up": _B_in["w_up"],
        "B_w_down": _B_in["w_down"],
    }

def reference(A_x, A_k_cache, A_v_cache, A_wq, A_wo, B_x, B_w_gate, B_w_up, B_w_down):
    def _A_ref(x, k_cache, v_cache, wq, wo):
        B, Sq, D = x.shape
        Hq, Dh = 32, 128
        Hkv = k_cache.shape[1]
        rep = Hq // Hkv
        q = (lambda x, *d: x.permute(*d))((x @ wq).reshape(B, Sq, Hq, Dh), 0, 2, 1, 3)
        k = (lambda x, n, axis: torch.repeat_interleave(x, n, dim=axis))(k_cache, rep, axis=1)
        v = (lambda x, n, axis: torch.repeat_interleave(x, n, dim=axis))(v_cache, rep, axis=1)
        scores = torch.einsum("bhqd,bhkd->bhqk", q, k) * (Dh ** -0.5)
        p = _softmax(scores, axis=-1)
        o = torch.einsum("bhqk,bhkd->bhqd", p, v)
        return (lambda x, *d: x.permute(*d))(o, 0, 2, 1, 3).reshape(B, Sq, Hq * Dh) @ wo

    def _B_ref(x, w_gate, w_up, w_down):
        return (_gelu(x @ w_gate) * (x @ w_up)) @ w_down

    x = A_x
    h = x + _A_ref(_layernorm(x, axis=-1), A_k_cache, A_v_cache, A_wq, A_wo)
    h2 = h + _B_ref(_layernorm(h, axis=-1), B_w_gate, B_w_up, B_w_down)
    return h2
```

```asm
; @launch grid=(256,1,1) block=(512,1,1) lds=123968
.amdgcn_target "amdgcn-amd-amdhsa--gfx950"
.text
.globl sequential_preLN__gqa_block_cached__geglu_ffn__decode_kernel
.p2align 8
.type sequential_preLN__gqa_block_cached__geglu_ffn__decode_kernel,@function
sequential_preLN__gqa_block_cached__geglu_ffn__decode_kernel:
  s_cmp_ge_u32 s2, 256
  s_cbranch_scc1 L_exit
  s_load_dwordx16 s[16:31], s[0:1], 0
  s_load_dwordx8 s[32:39], s[0:1], 64
  v_lshrrev_b32 v1, 6, v0
  v_and_b32 v0, 63, v0
  v_readfirstlane_b32 s3, v1
  s_lshr_b32 s43, s2, 3
  s_and_b32 s41, s43, 3
  s_lshr_b32 s4, s43, 2
  s_lshl_b32 s4, s4, 3
  s_and_b32 s5, s2, 7
  s_add_u32 s42, s4, s5
  s_mov_b32 s60, 0x05040100
  s_mov_b32 s61, 0x07060302
  s_mov_b32 s62, 0x3db504f3
  s_mov_b32 s63, 0x3fb8aa3b
  s_mov_b32 s97, 0xffff0000
  s_mov_b32 s98, 0xffffff00
  s_mov_b32 s99, 0xfffff000
  s_waitcnt lgkmcnt(0)
  s_cmp_ge_u32 s3, 4
  s_cbranch_scc1 L_hiwave
  s_setprio 3
  v_mov_b32 v6, 101376
  v_mov_b32 v7, 0
  ds_write_b32 v6, v7
  ds_write_b32 v6, v7 offset:16
  v_lshlrev_b32 v8, 2, v0
  v_add_u32 v8, 123520, v8
  v_mov_b32 v9, -1
  ds_write_b32 v8, v9
  ds_write_b32 v8, v9 offset:128
  v_mov_b32 v8, 123904
  ds_write_b32 v8, v7 offset:0
  ds_write_b32 v8, v7 offset:4
  ds_write_b32 v8, v7 offset:8
  ds_write_b32 v8, v7 offset:12
  s_waitcnt lgkmcnt(0)
  s_load_dword s40, s[38:39], 0
  s_mov_b32 s48, s22
  s_and_b32 s49, s23, 0xffff
  s_mov_b32 s50, 0x800000
  s_mov_b32 s51, 0x20000
  s_mov_b32 s52, s16
  s_and_b32 s53, s17, 0xffff
  s_mov_b32 s54, 0x800
  s_mov_b32 s55, 0x20000
  s_lshr_b32 s14, s2, 2
  s_and_b32 s15, s2, 3
  s_lshl_b32 s10, s15, 8
  s_lshl_b32 s11, s3, 6
  s_add_u32 s10, s10, s11
  v_lshlrev_b32 v2, 4, v0
  v_lshrrev_b32 v3, 3, v0
  v_lshlrev_b32 v4, 4, v3
  s_lshl_b32 s5, s10, 1
  buffer_load_dwordx4 v[16:19], v2, s[52:55], 0 offen
  buffer_load_dwordx4 v[20:23], v2, s[52:55], 0 offen offset:1024
  buffer_load_dwordx4 v[24:27], v4, s[52:55], s5 offen
  v_and_b32 v5, 7, v0
  v_lshlrev_b32 v5, 4, v5
  v_lshl_add_u32 v5, v3, 16, v5
  s_lshl_b32 s4, s10, 13
  s_lshl_b32 s6, s14, 7
  s_add_u32 s4, s4, s6
  buffer_load_dwordx4 v[64:67], v5, s[48:51], s4 offen nt
  s_add_u32 s4, s4, 8192
  buffer_load_dwordx4 v[68:71], v5, s[48:51], s4 offen nt
  s_add_u32 s4, s4, 8192
  buffer_load_dwordx4 v[72:75], v5, s[48:51], s4 offen nt
  s_add_u32 s4, s4, 8192
  buffer_load_dwordx4 v[76:79], v5, s[48:51], s4 offen nt
  s_add_u32 s4, s4, 8192
  buffer_load_dwordx4 v[80:83], v5, s[48:51], s4 offen nt
  s_add_u32 s4, s4, 8192
  buffer_load_dwordx4 v[84:87], v5, s[48:51], s4 offen nt
  s_add_u32 s4, s4, 8192
  buffer_load_dwordx4 v[88:91], v5, s[48:51], s4 offen nt
  s_add_u32 s4, s4, 8192
  buffer_load_dwordx4 v[92:95], v5, s[48:51], s4 offen nt
  s_cmp_ge_u32 s2, 224
  s_cbranch_scc1 L_tlo
  s_barrier
  s_waitcnt lgkmcnt(0)
  s_add_u32 s40, s40, 1
  s_and_b32 s45, s40, 0xff
  s_and_b32 s46, s40, 0xfff
  s_and_b32 s47, s40, 0xffff
  s_waitcnt vmcnt(8)
  v_lshlrev_b32 v32, 16, v16
  v_and_b32 v33, s97, v16
  v_lshlrev_b32 v34, 16, v17
  v_and_b32 v35, s97, v17
  v_lshlrev_b32 v36, 16, v18
  v_and_b32 v37, s97, v18
  v_lshlrev_b32 v38, 16, v19
  v_and_b32 v39, s97, v19
  v_lshlrev_b32 v40, 16, v20
  v_and_b32 v41, s97, v20
  v_lshlrev_b32 v42, 16, v21
  v_and_b32 v43, s97, v21
  v_lshlrev_b32 v44, 16, v22
  v_and_b32 v45, s97, v22
  v_lshlrev_b32 v46, 16, v23
  v_and_b32 v47, s97, v23
  v_add_f32 v48, v32, v33
  v_add_f32 v50, v34, v35
  v_add_f32 v48, v48, v36
  v_add_f32 v50, v50, v37
  v_add_f32 v48, v48, v38
  v_add_f32 v50, v50, v39
  v_add_f32 v48, v48, v40
  v_add_f32 v50, v50, v41
  v_add_f32 v48, v48, v42
  v_add_f32 v50, v50, v43
  v_add_f32 v48, v48, v44
  v_add_f32 v50, v50, v45
  v_add_f32 v48, v48, v46
  v_add_f32 v50, v50, v47
  v_add_f32 v48, v48, v50
  s_nop 1
  v_add_f32_dpp v48, v48, v48 quad_perm:[1,0,3,2] row_mask:0xf bank_mask:0xf
  s_nop 1
  v_add_f32_dpp v48, v48, v48 quad_perm:[2,3,0,1] row_mask:0xf bank_mask:0xf
  s_nop 1
  v_add_f32_dpp v48, v48, v48 row_half_mirror row_mask:0xf bank_mask:0xf
  s_nop 1
  v_add_f32_dpp v48, v48, v48 row_mirror row_mask:0xf bank_mask:0xf
  v_mov_b32 v49, v48
  s_nop 1
  v_permlane16_swap_b32 v49, v48
  v_add_f32 v48, v48, v49
  v_mov_b32 v49, v48
  s_nop 1
  v_permlane32_swap_b32 v49, v48
  v_add_f32 v48, v48, v49
  v_mul_f32 v48, 0x3a800000, v48
  v_sub_f32 v49, v32, v48
  v_mul_f32 v50, v49, v49
  v_sub_f32 v49, v33, v48
  v_fmac_f32 v50, v49, v49
  v_sub_f32 v49, v34, v48
  v_fmac_f32 v50, v49, v49
  v_sub_f32 v49, v35, v48
  v_fmac_f32 v50, v49, v49
  v_sub_f32 v49, v36, v48
  v_fmac_f32 v50, v49, v49
  v_sub_f32 v49, v37, v48
  v_fmac_f32 v50, v49, v49
  v_sub_f32 v49, v38, v48
  v_fmac_f32 v50, v49, v49
  v_sub_f32 v49, v39, v48
  v_fmac_f32 v50, v49, v49
  v_sub_f32 v49, v40, v48
  v_fmac_f32 v50, v49, v49
  v_sub_f32 v49, v41, v48
  v_fmac_f32 v50, v49, v49
  v_sub_f32 v49, v42, v48
  v_fmac_f32 v50, v49, v49
  v_sub_f32 v49, v43, v48
  v_fmac_f32 v50, v49, v49
  v_sub_f32 v49, v44, v48
  v_fmac_f32 v50, v49, v49
  v_sub_f32 v49, v45, v48
  v_fmac_f32 v50, v49, v49
  v_sub_f32 v49, v46, v48
  v_fmac_f32 v50, v49, v49
  v_sub_f32 v49, v47, v48
  v_fmac_f32 v50, v49, v49
  s_nop 1
  v_add_f32_dpp v50, v50, v50 quad_perm:[1,0,3,2] row_mask:0xf bank_mask:0xf
  s_nop 1
  v_add_f32_dpp v50, v50, v50 quad_perm:[2,3,0,1] row_mask:0xf bank_mask:0xf
  s_nop 1
  v_add_f32_dpp v50, v50, v50 row_half_mirror row_mask:0xf bank_mask:0xf
  s_nop 1
  v_add_f32_dpp v50, v50, v50 row_mirror row_mask:0xf bank_mask:0xf
  v_mov_b32 v49, v50
  s_nop 1
  v_permlane16_swap_b32 v49, v50
  v_add_f32 v50, v50, v49
  v_mov_b32 v49, v50
  s_nop 1
  v_permlane32_swap_b32 v49, v50
  v_add_f32 v50, v50, v49
  v_mul_f32 v50, 0x3a800000, v50
  v_cvt_pk_bf16_f32 v52, v48, v48
  v_and_b32 v52, s97, v52
  v_cvt_pk_bf16_f32 v50, v50, v50
  v_and_b32 v50, s97, v50
  v_add_f32 v50, 0x3727c5ac, v50
  v_cvt_pk_bf16_f32 v50, v50, v50
  v_and_b32 v50, s97, v50
  v_sqrt_f32 v50, v50
  s_nop 0
  v_cvt_pk_bf16_f32 v53, v50, v50
  v_and_b32 v53, s97, v53
  v_rcp_f32 v54, v53
  v_lshlrev_b32 v32, 16, v24
  v_and_b32 v33, s97, v24
  v_lshlrev_b32 v34, 16, v25
  v_and_b32 v35, s97, v25
  v_lshlrev_b32 v36, 16, v26
  v_and_b32 v37, s97, v26
  v_lshlrev_b32 v38, 16, v27
  v_and_b32 v39, s97, v27
  v_sub_f32 v56, v32, v52
  v_sub_f32 v57, v33, v52
  v_cvt_pk_bf16_f32 v57, v56, v57
  v_lshlrev_b32 v56, 16, v57
  v_and_b32 v57, s97, v57
  v_mul_f32 v58, v56, v54
  v_mul_f32 v59, v57, v54
  v_fma_f32 v56, -v58, v53, v56
  v_fma_f32 v57, -v59, v53, v57
  v_fmac_f32 v58, v56, v54
  v_fmac_f32 v59, v57, v54
  v_cvt_pk_bf16_f32 v16, v58, v59
  v_sub_f32 v56, v34, v52
  v_sub_f32 v57, v35, v52
  v_cvt_pk_bf16_f32 v57, v56, v57
  v_lshlrev_b32 v56, 16, v57
  v_and_b32 v57, s97, v57
  v_mul_f32 v58, v56, v54
  v_mul_f32 v59, v57, v54
  v_fma_f32 v56, -v58, v53, v56
  v_fma_f32 v57, -v59, v53, v57
  v_fmac_f32 v58, v56, v54
  v_fmac_f32 v59, v57, v54
  v_cvt_pk_bf16_f32 v17, v58, v59
  v_sub_f32 v56, v36, v52
  v_sub_f32 v57, v37, v52
  v_cvt_pk_bf16_f32 v57, v56, v57
  v_lshlrev_b32 v56, 16, v57
  v_and_b32 v57, s97, v57
  v_mul_f32 v58, v56, v54
  v_mul_f32 v59, v57, v54
  v_fma_f32 v56, -v58, v53, v56
  v_fma_f32 v57, -v59, v53, v57
  v_fmac_f32 v58, v56, v54
  v_fmac_f32 v59, v57, v54
  v_cvt_pk_bf16_f32 v18, v58, v59
  v_sub_f32 v56, v38, v52
  v_sub_f32 v57, v39, v52
  v_cvt_pk_bf16_f32 v57, v56, v57
  v_lshlrev_b32 v56, 16, v57
  v_and_b32 v57, s97, v57
  v_mul_f32 v58, v56, v54
  v_mul_f32 v59, v57, v54
  v_fma_f32 v56, -v58, v53, v56
  v_fma_f32 v57, -v59, v53, v57
  v_fmac_f32 v58, v56, v54
  v_fmac_f32 v59, v57, v54
  v_cvt_pk_bf16_f32 v19, v58, v59
  s_waitcnt vmcnt(0)
  v_perm_b32 v20, v68, v64, s60
  v_perm_b32 v21, v68, v64, s61
  v_dot2_f32_bf16 v32, v20, v16, 0
  v_dot2_f32_bf16 v33, v21, v16, 0
  v_perm_b32 v22, v69, v65, s60
  v_perm_b32 v23, v69, v65, s61
  v_dot2_f32_bf16 v34, v22, v16, 0
  v_dot2_f32_bf16 v35, v23, v16, 0
  v_perm_b32 v20, v70, v66, s60
  v_perm_b32 v21, v70, v66, s61
  v_dot2_f32_bf16 v36, v20, v16, 0
  v_dot2_f32_bf16 v37, v21, v16, 0
  v_perm_b32 v22, v71, v67, s60
  v_perm_b32 v23, v71, v67, s61
  v_dot2_f32_bf16 v38, v22, v16, 0
  v_dot2_f32_bf16 v39, v23, v16, 0
  v_perm_b32 v20, v76, v72, s60
  v_perm_b32 v21, v76, v72, s61
  v_dot2_f32_bf16 v32, v20, v17, v32
  v_dot2_f32_bf16 v33, v21, v17, v33
  v_perm_b32 v22, v77, v73, s60
  v_perm_b32 v23, v77, v73, s61
  v_dot2_f32_bf16 v34, v22, v17, v34
  v_dot2_f32_bf16 v35, v23, v17, v35
  v_perm_b32 v20, v78, v74, s60
  v_perm_b32 v21, v78, v74, s61
  v_dot2_f32_bf16 v36, v20, v17, v36
  v_dot2_f32_bf16 v37, v21, v17, v37
  v_perm_b32 v22, v79, v75, s60
  v_perm_b32 v23, v79, v75, s61
  v_dot2_f32_bf16 v38, v22, v17, v38
  v_dot2_f32_bf16 v39, v23, v17, v39
  v_perm_b32 v20, v84, v80, s60
  v_perm_b32 v21, v84, v80, s61
  v_dot2_f32_bf16 v32, v20, v18, v32
  v_dot2_f32_bf16 v33, v21, v18, v33
  v_perm_b32 v22, v85, v81, s60
  v_perm_b32 v23, v85, v81, s61
  v_dot2_f32_bf16 v34, v22, v18, v34
  v_dot2_f32_bf16 v35, v23, v18, v35
  v_perm_b32 v20, v86, v82, s60
  v_perm_b32 v21, v86, v82, s61
  v_dot2_f32_bf16 v36, v20, v18, v36
  v_dot2_f32_bf16 v37, v21, v18, v37
  v_perm_b32 v22, v87, v83, s60
  v_perm_b32 v23, v87, v83, s61
  v_dot2_f32_bf16 v38, v22, v18, v38
  v_dot2_f32_bf16 v39, v23, v18, v39
  v_perm_b32 v20, v92, v88, s60
  v_perm_b32 v21, v92, v88, s61
  v_dot2_f32_bf16 v32, v20, v19, v32
  v_dot2_f32_bf16 v33, v21, v19, v33
  v_perm_b32 v22, v93, v89, s60
  v_perm_b32 v23, v93, v89, s61
  v_dot2_f32_bf16 v34, v22, v19, v34
  v_dot2_f32_bf16 v35, v23, v19, v35
  v_perm_b32 v20, v94, v90, s60
  v_perm_b32 v21, v94, v90, s61
  v_dot2_f32_bf16 v36, v20, v19, v36
  v_dot2_f32_bf16 v37, v21, v19, v37
  v_perm_b32 v22, v95, v91, s60
  v_perm_b32 v23, v95, v91, s61
  v_dot2_f32_bf16 v38, v22, v19, v38
  v_dot2_f32_bf16 v39, v23, v19, v39
  v_permlane32_swap_b32 v32, v36
  v_permlane32_swap_b32 v33, v37
  v_permlane32_swap_b32 v34, v38
  v_permlane32_swap_b32 v35, v39
  v_add_f32 v32, v32, v36
  v_add_f32 v33, v33, v37
  v_add_f32 v34, v34, v38
  v_add_f32 v35, v35, v39
  s_nop 0
  v_permlane16_swap_b32 v32, v34
  v_permlane16_swap_b32 v33, v35
  v_add_f32 v32, v32, v34
  v_add_f32 v33, v33, v35
  s_nop 0
  v_add_f32_dpp v32, v32, v32 row_ror:8 row_mask:0xf bank_mask:0xf
  v_add_f32_dpp v33, v33, v33 row_ror:8 row_mask:0xf bank_mask:0xf
  v_and_b32 v20, 7, v0
  v_lshlrev_b32 v20, 5, v20
  v_lshrrev_b32 v21, 5, v0
  v_lshl_add_u32 v20, v21, 4, v20
  v_bfe_u32 v21, v0, 4, 1
  v_lshl_add_u32 v20, v21, 3, v20
  s_lshl_b32 s4, s3, 8
  s_add_u32 s4, s4, 100352
  v_add_u32 v20, s4, v20
  ds_write_b64 v20, v[32:33]
  s_waitcnt lgkmcnt(0)
  s_mov_b64 exec, 1
  v_mov_b32 v7, 1
  ds_add_rtn_u32 v8, v6, v7
  s_waitcnt lgkmcnt(0)
  v_readfirstlane_b32 s4, v8
  s_mov_b64 exec, -1
  s_cmp_eq_u32 s4, 3
  s_cbranch_scc0 L_qnl_1
  s_mov_b64 exec, 0xffff
  v_add_u32 v20, 100352, v2
  ds_read_b128 v[32:35], v20 offset:0
  ds_read_b128 v[36:39], v20 offset:256
  ds_read_b128 v[40:43], v20 offset:512
  ds_read_b128 v[44:47], v20 offset:768
  s_lshr_b32 s4, s14, 4
  s_lshl_b32 s4, s4, 14
  s_lshl_b32 s5, s15, 12
  s_add_u32 s4, s4, s5
  s_and_b32 s5, s14, 15
  s_lshl_b32 s5, s5, 8
  s_add_u32 s4, s4, s5
  s_add_u32 s4, s4, 4096
  v_add_u32 v21, s4, v2
  v_mov_b32 v22, s45
  s_and_b32 s5, s2, 63
  s_cmp_eq_u32 s5, 0
  s_cbranch_scc0 L_noc_2
  s_lshl_b32 s5, s2, 5
  s_add_u32 s5, s5, 98304
  v_lshlrev_b32 v23, 8, v0
  v_and_b32 v23, 0x7ff, v23
  v_add_u32 v23, s5, v23
  v_mov_b32 v24, 0
  global_store_dword v23, v24, s[38:39] sc1
  s_waitcnt vmcnt(0)
L_noc_2:
  s_waitcnt lgkmcnt(0)
  v_add_f32 v32, v32, v36
  v_add_f32 v40, v40, v44
  v_add_f32 v33, v33, v37
  v_add_f32 v41, v41, v45
  v_add_f32 v34, v34, v38
  v_add_f32 v42, v42, v46
  v_add_f32 v35, v35, v39
  v_add_f32 v43, v43, v47
  v_add_f32 v32, v32, v40
  v_add_f32 v33, v33, v41
  v_add_f32 v34, v34, v42
  v_add_f32 v35, v35, v43
  v_and_or_b32 v32, v32, s98, v22
  v_and_or_b32 v33, v33, s98, v22
  v_and_or_b32 v34, v34, s98, v22
  v_and_or_b32 v35, v35, s98, v22
  global_store_dwordx4 v21, v[32:35], s[38:39] sc1
  s_mov_b64 exec, -1
L_qnl_1:
  s_lshl_b32 s4, s41, 14
  s_lshl_b32 s5, s3, 10
  s_add_u32 s4, s4, s5
  s_add_u32 s4, s4, 8192
  v_add_u32 v20, s4, v2
  v_add_u32 v21, 8192, v20
  v_mov_b32 v22, s45
  s_mov_b32 s4, 0xff
  s_mov_b32 s96, 0
L_mp_3:
  global_load_dwordx4 v[32:35], v20, s[38:39] offset:-4096 sc1
  global_load_dwordx4 v[36:39], v20, s[38:39] sc1
  global_load_dwordx4 v[40:43], v21, s[38:39] offset:-4096 sc1
  global_load_dwordx4 v[44:47], v21, s[38:39] sc1
  s_waitcnt vmcnt(0)
  v_xor_b32 v32, v22, v32
  v_xor_b32 v33, v22, v33
  v_xor_b32 v34, v22, v34
  v_xor_b32 v35, v22, v35
  v_xor_b32 v36, v22, v36
  v_xor_b32 v37, v22, v37
  v_xor_b32 v38, v22, v38
  v_xor_b32 v39, v22, v39
  v_xor_b32 v40, v22, v40
  v_xor_b32 v41, v22, v41
  v_xor_b32 v42, v22, v42
  v_xor_b32 v43, v22, v43
  v_xor_b32 v44, v22, v44
  v_xor_b32 v45, v22, v45
  v_xor_b32 v46, v22, v46
  v_xor_b32 v47, v22, v47
  v_or_b32 v23, v32, v33
  v_or3_b32 v23, v23, v34, v35
  v_or3_b32 v23, v23, v36, v37
  v_or3_b32 v23, v23, v38, v39
  v_or3_b32 v23, v23, v40, v41
  v_or3_b32 v23, v23, v42, v43
  v_or3_b32 v23, v23, v44, v45
  v_or3_b32 v23, v23, v46, v47
  v_and_b32 v23, s4, v23
  v_cmp_ne_u32 vcc, 0, v23
  s_and_b64 exec, exec, vcc
  s_cbranch_execz L_mok_4
  s_add_u32 s96, s96, 1
  s_cmp_lt_u32 s96, 400000
  s_cbranch_scc1 L_mp_3
  s_branch L_abort
L_mok_4:
  s_mov_b64 exec, -1
  v_add_f32 v32, v32, v36
  v_add_f32 v40, v40, v44
  v_add_f32 v33, v33, v37
  v_add_f32 v41, v41, v45
  v_add_f32 v34, v34, v38
  v_add_f32 v42, v42, v46
  v_add_f32 v35, v35, v39
  v_add_f32 v43, v43, v47
  v_add_f32 v32, v32, v40
  v_add_f32 v33, v33, v41
  v_add_f32 v34, v34, v42
  v_add_f32 v35, v35, v43
  v_cvt_pk_bf16_f32 v32, v32, v33
  v_cvt_pk_bf16_f32 v33, v34, v35
  s_lshl_b32 s4, s3, 9
  s_add_u32 s4, s4, 98304
  v_lshlrev_b32 v20, 3, v0
  v_add_u32 v20, s4, v20
  ds_write_b64 v20, v[32:33]
  s_waitcnt lgkmcnt(0)
  s_barrier
  s_and_b32 s4, s2, 7
  s_mul_i32 s4, s4, 7
  s_lshr_b32 s5, s43, 2
  s_add_u32 s44, s4, s5
  s_and_b32 s100, s43, 3
  s_lshl_b32 s8, s44, 17
  s_add_u32 s56, s32, s8
  s_addc_u32 s57, s33, 0
  s_and_b32 s57, s57, 0xffff
  s_mov_b32 s58, 0x20000
  s_mov_b32 s59, 0x20000
  v_lshrrev_b32 v50, 3, v0
  v_lshlrev_b32 v50, 14, v50
  v_and_b32 v51, 7, v0
  v_lshl_add_u32 v50, v51, 4, v50
  s_lshl_b32 s8, s100, 9
  s_lshl_b32 s9, s3, 7
  s_add_u32 s8, s8, s9
  v_add_u32 v50, s8, v50
  v_lshrrev_b32 v12, 5, v0
  s_lshl_b32 s4, s3, 1
  v_add_u32 v12, s4, v12
  v_and_b32 v13, 31, v0
  v_mul_u32_u24 v14, 528, v12
  v_lshl_add_u32 v14, v13, 4, v14
  v_add_u32 v14, 101440, v14
  v_lshlrev_b32 v15, 3, v12
  v_add_u32 v15, 105664, v15
  s_lshl_b32 s4, s41, 6
  s_add_u32 s4, s4, s42
  s_mul_i32 s4, s4, 4224
  s_add_u32 s4, s4, 262144
  s_lshl_b32 s5, s3, 10
  s_add_u32 s5, s5, s4
  v_lshlrev_b32 v25, 4, v0
  v_add_u32 v25, s5, v25
  v_mov_b32 v26, s46
  v_lshlrev_b32 v24, 4, v12
  s_add_u32 s4, s4, 4096
  v_add_u32 v24, s4, v24
  s_mov_b64 exec, 1
  s_lshr_b32 s15, s42, 3
  s_lshl_b32 s4, s41, 11
  s_lshl_b32 s5, s15, 8
  s_add_u32 s4, s4, s5
  s_add_u32 s4, s4, 98304
  v_mov_b32 v32, s4
  v_mov_b32 v33, 1
  s_lshl_b32 s4, s3, 2
  s_add_u32 s4, s4, 123904
  v_mov_b32 v34, s4
  s_mul_i32 s14, s3, 96
  s_add_u32 s14, s14, 123520
  s_mov_b32 s8, 0
  s_mov_b32 s96, 0
L_sch_5:
  ds_read_b32 v35, v34
  s_waitcnt lgkmcnt(0)
  v_readfirstlane_b32 s9, v35
  s_sub_u32 s9, s8, s9
  s_cmp_le_i32 s9, 2
  s_cbranch_scc1 L_need_6
  s_sleep 2
  s_add_u32 s96, s96, 1
  s_cmp_lt_u32 s96, 1600000
  s_cbranch_scc1 L_sch_5
  s_branch L_abort
L_need_6:
  global_atomic_add v36, v32, v33, s[38:39] sc0 sc1
  s_waitcnt vmcnt(0)
  v_readfirstlane_b32 s10, v36
  s_add_u32 s11, s10, 0
  s_mul_i32 s11, s11, 7
  s_add_u32 s11, s11, s15
  s_add_u32 s11, s11, 1120
  s_cmp_lt_u32 s11, 2048
  s_cselect_b32 s12, 1, 0
  s_lshl_b32 s11, s11, 13
  s_cmp_eq_u32 s12, 1
  s_cselect_b32 s11, s11, 0x2000000
  s_lshl_b32 s13, s8, 2
  s_add_u32 s13, s13, s14
  v_mov_b32 v37, s13
  v_mov_b32 v38, s11
  ds_write_b32 v37, v38 offset:0
  s_add_u32 s8, s8, 1
  s_cmp_eq_u32 s12, 1
  s_cbranch_scc0 L_schf_7
  s_cmp_lt_u32 s8, 21
  s_cbranch_scc1 L_sch_5
L_schf_7:
  s_lshl_b32 s13, s8, 2
  s_add_u32 s13, s13, s14
  v_mov_b32 v37, s13
  v_mov_b32 v38, 0x2000000
  ds_write_b32 v37, v38
  s_waitcnt lgkmcnt(0)
  s_mov_b64 exec, -1
  s_barrier
  ds_read_b64 v[16:17], v15 offset:0
  ds_read_b64 v[18:19], v15 offset:4288
  ds_read_b64 v[20:21], v15 offset:8576
  ds_read_b64 v[22:23], v15 offset:12864
  ds_read_b128 v[32:35], v14 offset:0
  ds_read_b128 v[36:39], v14 offset:4288
  ds_read_b128 v[40:43], v14 offset:8576
  ds_read_b128 v[44:47], v14 offset:12864
  s_waitcnt lgkmcnt(4)
  v_max3_f32 v27, v16, v18, v20
  v_max_f32 v27, v27, v22
  v_sub_f32 v16, v16, v27
  v_sub_f32 v18, v18, v27
  v_sub_f32 v20, v20, v27
  v_sub_f32 v22, v22, v27
  v_mul_f32 v16, s63, v16
  v_mul_f32 v18, s63, v18
  v_mul_f32 v20, s63, v20
  v_mul_f32 v22, s63, v22
  v_exp_f32 v16, v16
  v_exp_f32 v18, v18
  v_exp_f32 v20, v20
  v_exp_f32 v22, v22
  v_and_or_b32 v8, v27, s99, v26
  v_mul_f32 v28, v16, v17
  v_fmac_f32 v28, v18, v19
  v_fmac_f32 v28, v20, v21
  v_fmac_f32 v28, v22, v23
  v_mov_b32 v10, v8
  v_and_or_b32 v9, v28, s99, v26
  v_mov_b32 v11, v9
  s_mov_b32 exec_lo, 1
  s_mov_b32 exec_hi, 1
  global_store_dwordx4 v24, v[8:11], s[38:39] sc1
  s_mov_b64 exec, -1
  s_waitcnt lgkmcnt(0)
  v_mul_f32 v32, v16, v32
  v_mul_f32 v33, v16, v33
  v_mul_f32 v34, v16, v34
  v_mul_f32 v35, v16, v35
  v_fmac_f32 v32, v18, v36
  v_fmac_f32 v33, v18, v37
  v_fmac_f32 v34, v18, v38
  v_fmac_f32 v35, v18, v39
  v_fmac_f32 v32, v20, v40
  v_fmac_f32 v33, v20, v41
  v_fmac_f32 v34, v20, v42
  v_fmac_f32 v35, v20, v43
  v_fmac_f32 v32, v22, v44
  v_fmac_f32 v33, v22, v45
  v_fmac_f32 v34, v22, v46
  v_fmac_f32 v35, v22, v47
  v_and_or_b32 v32, v32, s99, v26
  v_and_or_b32 v33, v33, s99, v26
  v_and_or_b32 v34, v34, s99, v26
  v_and_or_b32 v35, v35, s99, v26
  global_store_dwordx4 v25, v[32:35], s[38:39] sc1
  s_barrier
  v_lshlrev_b32 v2, 4, v0
  s_lshl_b32 s8, s44, 11
  s_add_u32 s8, s8, 2555904
  v_add_u32 v17, s8, v2
  s_lshl_b32 s7, s100, 9
  v_add_u32 v16, s7, v17
  s_lshl_b32 s8, s44, 2
  s_add_u32 s8, s8, s100
  s_mul_i32 s8, s8, 1152
  s_lshl_b32 s7, s3, 8
  s_add_u32 s8, s8, s7
  s_add_u32 s8, s8, 2686976
  v_and_b32 v18, 7, v0
  v_lshlrev_b32 v18, 5, v18
  v_lshrrev_b32 v19, 5, v0
  v_lshl_add_u32 v18, v19, 4, v18
  v_add_u32 v18, s8, v18
  v_and_b32 v19, 15, v0
  v_lshlrev_b32 v19, 2, v19
  v_lshrrev_b32 v20, 5, v0
  v_lshl_add_u32 v19, v20, 1, v19
  v_bfe_u32 v20, v0, 4, 1
  v_add_u32 v19, v19, v20
  v_lshlrev_b32 v19, 1, v19
  s_lshl_b32 s7, s3, 7
  s_add_u32 s7, s7, 123008
  v_add_u32 v19, s7, v19
  v_lshrrev_b32 v20, 3, v0
  v_lshlrev_b32 v20, 4, v20
  v_add_u32 v20, s7, v20
  v_mov_b32 v21, s45
  v_mov_b32 v22, s46
  v_add_u32 v23, 118592, v2
  v_mov_b32 v24, 122944
  s_barrier
  s_mov_b32 s8, 0
  buffer_load_dwordx4 v[128:131], v50, s[56:59], s8 offen offset:0 nt
  buffer_load_dwordx4 v[132:135], v50, s[56:59], s8 offen offset:2048 nt
  s_mov_b32 s8, 4096
  buffer_load_dwordx4 v[136:139], v50, s[56:59], s8 offen offset:0 nt
  buffer_load_dwordx4 v[140:143], v50, s[56:59], s8 offen offset:2048 nt
  s_mov_b32 s8, 8192
  buffer_load_dwordx4 v[144:147], v50, s[56:59], s8 offen offset:0 nt
  buffer_load_dwordx4 v[148:151], v50, s[56:59], s8 offen offset:2048 nt
  s_mov_b32 s8, 12288
  buffer_load_dwordx4 v[152:155], v50, s[56:59], s8 offen offset:0 nt
  buffer_load_dwordx4 v[156:159], v50, s[56:59], s8 offen offset:2048 nt
  s_waitcnt vmcnt(0)
  v_perm_b32 v8, v132, v128, s60
  v_perm_b32 v132, v132, v128, s61
  v_mov_b32 v128, v8
  v_perm_b32 v9, v133, v129, s60
  v_perm_b32 v133, v133, v129, s61
  v_mov_b32 v129, v9
  v_perm_b32 v8, v134, v130, s60
  v_perm_b32 v134, v134, v130, s61
  v_mov_b32 v130, v8
  v_perm_b32 v9, v135, v131, s60
  v_perm_b32 v135, v135, v131, s61
  v_mov_b32 v131, v9
  v_perm_b32 v8, v140, v136, s60
  v_perm_b32 v140, v140, v136, s61
  v_mov_b32 v136, v8
  v_perm_b32 v9, v141, v137, s60
  v_perm_b32 v141, v141, v137, s61
  v_mov_b32 v137, v9
  v_perm_b32 v8, v142, v138, s60
  v_perm_b32 v142, v142, v138, s61
  v_mov_b32 v138, v8
  v_perm_b32 v9, v143, v139, s60
  v_perm_b32 v143, v143, v139, s61
  v_mov_b32 v139, v9
  v_perm_b32 v8, v148, v144, s60
  v_perm_b32 v148, v148, v144, s61
  v_mov_b32 v144, v8
  v_perm_b32 v9, v149, v145, s60
  v_perm_b32 v149, v149, v145, s61
  v_mov_b32 v145, v9
  v_perm_b32 v8, v150, v146, s60
  v_perm_b32 v150, v150, v146, s61
  v_mov_b32 v146, v8
  v_perm_b32 v9, v151, v147, s60
  v_perm_b32 v151, v151, v147, s61
  v_mov_b32 v147, v9
  v_perm_b32 v8, v156, v152, s60
  v_perm_b32 v156, v156, v152, s61
  v_mov_b32 v152, v8
  v_perm_b32 v9, v157, v153, s60
  v_perm_b32 v157, v157, v153, s61
  v_mov_b32 v153, v9
  v_perm_b32 v8, v158, v154, s60
  v_perm_b32 v158, v158, v154, s61
  v_mov_b32 v154, v8
  v_perm_b32 v9, v159, v155, s60
  v_perm_b32 v159, v159, v155, s61
  v_mov_b32 v155, v9
  s_barrier
  s_cmp_eq_u32 s3, 0
  s_cbranch_scc0 L_enp_8
  s_mov_b32 exec_hi, 0
  ds_read_b64 v[10:11], v24
  ds_read_b128 v[32:35], v23 offset:0
  ds_read_b128 v[36:39], v23 offset:1088
  ds_read_b128 v[40:43], v23 offset:2176
  ds_read_b128 v[44:47], v23 offset:3264
  ds_read_b128 v[48:51], v23 offset:512
  ds_read_b128 v[52:55], v23 offset:1600
  ds_read_b128 v[56:59], v23 offset:2688
  ds_read_b128 v[60:63], v23 offset:3776
  s_waitcnt lgkmcnt(4)
  v_add_f32 v32, v32, v36
  v_add_f32 v40, v40, v44
  v_add_f32 v33, v33, v37
  v_add_f32 v41, v41, v45
  v_add_f32 v34, v34, v38
  v_add_f32 v42, v42, v46
  v_add_f32 v35, v35, v39
  v_add_f32 v43, v43, v47
  v_add_f32 v32, v32, v40
  v_add_f32 v33, v33, v41
  v_add_f32 v34, v34, v42
  v_add_f32 v35, v35, v43
  s_waitcnt lgkmcnt(0)
  v_add_f32 v48, v48, v52
  v_add_f32 v56, v56, v60
  v_add_f32 v49, v49, v53
  v_add_f32 v57, v57, v61
  v_add_f32 v50, v50, v54
  v_add_f32 v58, v58, v62
  v_add_f32 v51, v51, v55
  v_add_f32 v59, v59, v63
  v_add_f32 v48, v48, v56
  v_add_f32 v49, v49, v57
  v_add_f32 v50, v50, v58
  v_add_f32 v51, v51, v59
  v_fma_f32 v32, -v10, v48, v32
  v_fma_f32 v33, -v10, v49, v33
  v_fma_f32 v34, -v10, v50, v34
  v_fma_f32 v35, -v10, v51, v35
  v_mul_f32 v32, v11, v32
  v_mul_f32 v33, v11, v33
  v_mul_f32 v34, v11, v34
  v_mul_f32 v35, v11, v35
  v_and_or_b32 v32, v32, s98, v21
  v_and_or_b32 v33, v33, s98, v21
  v_and_or_b32 v34, v34, s98, v21
  v_and_or_b32 v35, v35, s98, v21
  global_store_dwordx4 v16, v[32:35], s[38:39] sc1
  s_mov_b64 exec, -1
L_enp_8:
  s_mov_b32 s9, 0xff
  s_mov_b32 s96, 0
L_mp_9:
  global_load_dwordx4 v[32:35], v17, s[38:39] sc1
  global_load_dwordx4 v[36:39], v17, s[38:39] offset:1024 sc1
  s_waitcnt vmcnt(0)
  v_xor_b32 v32, v21, v32
  v_xor_b32 v33, v21, v33
  v_xor_b32 v34, v21, v34
  v_xor_b32 v35, v21, v35
  v_xor_b32 v36, v21, v36
  v_xor_b32 v37, v21, v37
  v_xor_b32 v38, v21, v38
  v_xor_b32 v39, v21, v39
  v_or_b32 v8, v32, v33
  v_or3_b32 v8, v8, v34, v35
  v_or3_b32 v8, v8, v36, v37
  v_or3_b32 v8, v8, v38, v39
  v_and_b32 v8, s9, v8
  v_cmp_ne_u32 vcc, 0, v8
  s_and_b64 exec, exec, vcc
  s_cbranch_execz L_mok_10
  s_add_u32 s96, s96, 1
  s_cmp_lt_u32 s96, 400000
  s_cbranch_scc1 L_mp_9
  s_branch L_abort
L_mok_10:
  s_mov_b64 exec, -1
  v_add_f32 v32, v32, v36
  v_add_f32 v33, v33, v37
  v_add_f32 v34, v34, v38
  v_add_f32 v35, v35, v39
  s_nop 0
  v_permlane32_swap_b32 v32, v34
  v_permlane32_swap_b32 v33, v35
  v_add_f32 v32, v32, v34
  v_add_f32 v33, v33, v35
  s_nop 1
  v_permlane16_swap_b32 v32, v33
  v_cvt_pk_bf16_f32 v32, v32, v32
  v_and_b32 v32, s97, v32
  v_cvt_pk_bf16_f32 v33, v33, v33
  v_and_b32 v33, s97, v33
  v_mul_f32 v36, v32, v32
  v_mov_b32 v38, 0x3d372713
  v_fma_f32 v36, v36, v38, 1.0
  v_mul_f32 v36, v36, v32
  v_mul_f32 v36, 0xc0135761, v36
  v_exp_f32 v36, v36
  s_nop 0
  v_add_f32 v36, 1.0, v36
  v_rcp_f32 v36, v36
  s_nop 0
  v_mul_f32 v36, v32, v36
  v_cvt_pk_bf16_f32 v36, v36, v36
  v_and_b32 v36, s97, v36
  v_mul_f32 v36, v36, v33
  v_cvt_pk_bf16_f32 v36, v36, v36
  ds_write_b16 v19, v36
  s_waitcnt lgkmcnt(0)
  ds_read_b128 v[44:47], v20
  s_waitcnt lgkmcnt(0)
  v_dot2_f32_bf16 v32, v128, v44, 0
  v_dot2_f32_bf16 v33, v132, v44, 0
  v_dot2_f32_bf16 v34, v129, v44, 0
  v_dot2_f32_bf16 v35, v133, v44, 0
  v_dot2_f32_bf16 v36, v130, v44, 0
  v_dot2_f32_bf16 v37, v134, v44, 0
  v_dot2_f32_bf16 v38, v131, v44, 0
  v_dot2_f32_bf16 v39, v135, v44, 0
  v_dot2c_f32_bf16 v32, v136, v45
  v_dot2c_f32_bf16 v33, v140, v45
  v_dot2c_f32_bf16 v34, v137, v45
  v_dot2c_f32_bf16 v35, v141, v45
  v_dot2c_f32_bf16 v36, v138, v45
  v_dot2c_f32_bf16 v37, v142, v45
  v_dot2c_f32_bf16 v38, v139, v45
  v_dot2c_f32_bf16 v39, v143, v45
  v_dot2c_f32_bf16 v32, v144, v46
  v_dot2c_f32_bf16 v33, v148, v46
  v_dot2c_f32_bf16 v34, v145, v46
  v_dot2c_f32_bf16 v35, v149, v46
  v_dot2c_f32_bf16 v36, v146, v46
  v_dot2c_f32_bf16 v37, v150, v46
  v_dot2c_f32_bf16 v38, v147, v46
  v_dot2c_f32_bf16 v39, v151, v46
  v_dot2c_f32_bf16 v32, v152, v47
  v_dot2c_f32_bf16 v33, v156, v47
  v_dot2c_f32_bf16 v34, v153, v47
  v_dot2c_f32_bf16 v35, v157, v47
  v_dot2c_f32_bf16 v36, v154, v47
  v_dot2c_f32_bf16 v37, v158, v47
  v_dot2c_f32_bf16 v38, v155, v47
  v_dot2c_f32_bf16 v39, v159, v47
  v_permlane32_swap_b32 v32, v36
  v_permlane32_swap_b32 v33, v37
  v_permlane32_swap_b32 v34, v38
  v_permlane32_swap_b32 v35, v39
  v_add_f32 v32, v32, v36
  v_add_f32 v33, v33, v37
  v_add_f32 v34, v34, v38
  v_add_f32 v35, v35, v39
  v_add_f32_dpp v32, v32, v32 row_ror:8 row_mask:0xf bank_mask:0xf
  v_add_f32_dpp v33, v33, v33 row_ror:8 row_mask:0xf bank_mask:0xf
  v_add_f32_dpp v34, v34, v34 row_ror:8 row_mask:0xf bank_mask:0xf
  v_add_f32_dpp v35, v35, v35 row_ror:8 row_mask:0xf bank_mask:0xf
  v_mov_b32 v40, v32
  v_mov_b32 v41, v33
  v_mov_b32 v42, v34
  v_mov_b32 v43, v35
  v_permlane16_swap_b32 v40, v32
  v_permlane16_swap_b32 v41, v33
  v_permlane16_swap_b32 v42, v34
  v_permlane16_swap_b32 v43, v35
  v_add_f32 v32, v32, v40
  v_add_f32 v33, v33, v41
  v_add_f32 v34, v34, v42
  v_add_f32 v35, v35, v43
  v_and_or_b32 v32, v32, s99, v22
  v_and_or_b32 v33, v33, s99, v22
  v_and_or_b32 v34, v34, s99, v22
  v_and_or_b32 v35, v35, s99, v22
  s_mov_b32 exec_lo, 0xff
  s_mov_b32 exec_hi, 0xff
  global_store_dwordx4 v18, v[32:35], s[38:39] sc1
  s_mov_b64 exec, -1
  s_endpgm
L_hiwave:
  s_cmp_ge_u32 s2, 224
  s_cbranch_scc1 L_thi
  s_load_dword s40, s[38:39], 0
  s_sub_u32 s3, s3, 4
  s_mul_i32 s4, s3, 56
  s_add_u32 s4, s4, s42
  s_lshl_b32 s12, s4, 13
  s_lshl_b32 s4, s41, 24
  s_add_u32 s48, s18, s4
  s_addc_u32 s49, s19, 0
  s_and_b32 s49, s49, 0xffff
  s_mov_b32 s50, 0x1000000
  s_mov_b32 s51, 0x20000
  s_add_u32 s52, s20, s4
  s_addc_u32 s53, s21, 0
  s_and_b32 s53, s53, 0xffff
  s_mov_b32 s54, 0x1000000
  s_mov_b32 s55, 0x20000
  s_and_b32 s4, s2, 7
  s_mul_i32 s4, s4, 7
  s_lshr_b32 s5, s43, 2
  s_add_u32 s44, s4, s5
  s_and_b32 s100, s43, 3
  v_lshrrev_b32 v56, 3, v0
  s_mov_b32 s5, 57344
  v_mul_lo_u32 v56, v56, s5
  v_and_b32 v57, 7, v0
  v_lshl_add_u32 v56, v57, 4, v56
  s_lshl_b32 s6, s100, 8
  s_lshl_b32 s7, s3, 6
  s_add_u32 s6, s6, s7
  s_mul_i32 s7, s6, 7168
  s_lshl_b32 s4, s44, 7
  s_add_u32 s14, s7, s4
  s_mov_b32 s56, s28
  s_and_b32 s57, s29, 0xffff
  s_mov_b32 s58, 0x700000
  s_mov_b32 s59, 0x20000
  s_mov_b32 s15, 0
  s_mul_i32 s101, s3, 24576
  v_lshrrev_b32 v14, 4, v0
  v_and_b32 v15, 15, v0
  v_lshlrev_b32 v11, 2, v14
  v_add_u32 v11, 0, v11
  v_xor_b32 v11, v11, v15
  v_lshlrev_b32 v11, 4, v11
  v_lshl_add_u32 v2, v14, 8, v11
  v_lshlrev_b32 v11, 2, v14
  v_add_u32 v11, 1, v11
  v_xor_b32 v11, v11, v15
  v_lshlrev_b32 v11, 4, v11
  v_lshl_add_u32 v3, v14, 8, v11
  v_lshlrev_b32 v11, 2, v14
  v_add_u32 v11, 2, v11
  v_xor_b32 v11, v11, v15
  v_lshlrev_b32 v11, 4, v11
  v_lshl_add_u32 v4, v14, 8, v11
  v_lshlrev_b32 v11, 2, v14
  v_add_u32 v11, 3, v11
  v_xor_b32 v11, v11, v15
  v_lshlrev_b32 v11, 4, v11
  v_lshl_add_u32 v5, v14, 8, v11
  v_lshlrev_b32 v6, 4, v0
  v_and_b32 v16, 3, v15
  v_lshrrev_b32 v17, 2, v15
  v_lshl_add_u32 v18, v16, 2, v17
  v_lshlrev_b32 v18, 8, v18
  v_add_u32 v18, s101, v18
  v_xor_b32 v19, v14, v16
  v_xor_b32 v20, 0, v17
  v_lshl_add_u32 v20, v20, 2, v19
  v_lshl_add_u32 v7, v20, 4, v18
  v_xor_b32 v20, 1, v17
  v_lshl_add_u32 v20, v20, 2, v19
  v_lshl_add_u32 v8, v20, 4, v18
  v_xor_b32 v20, 2, v17
  v_lshl_add_u32 v20, v20, 2, v19
  v_lshl_add_u32 v9, v20, 4, v18
  v_xor_b32 v20, 3, v17
  v_lshl_add_u32 v20, v20, 2, v19
  v_lshl_add_u32 v10, v20, 4, v18
  v_and_b32 v21, 7, v15
  v_lshlrev_b32 v21, 8, v21
  v_lshl_add_u32 v21, v14, 4, v21
  v_add_u32 v21, 98304, v21
  s_mul_i32 s6, s3, 4288
  s_add_u32 s6, s6, 101440
  v_mul_u32_u24 v22, 528, v15
  v_lshl_add_u32 v22, v14, 7, v22
  v_add_u32 v1, s6, v22
  v_mov_b32 v15, v21
  s_barrier
  s_mov_b32 s10, s12
  s_add_u32 s5, s10, 4096
  s_add_u32 m0, s101, 0
  s_nop 0
  buffer_load_dwordx4 v2, s[48:51], s10 offen offset:0 nt lds
  buffer_load_dwordx4 v3, s[48:51], s10 offen offset:1024 nt lds
  buffer_load_dwordx4 v4, s[48:51], s10 offen offset:2048 nt lds
  buffer_load_dwordx4 v5, s[48:51], s10 offen offset:3072 nt lds
  s_add_u32 m0, s101, 4096
  s_nop 0
  buffer_load_dwordx4 v2, s[48:51], s5 offen offset:0 nt lds
  buffer_load_dwordx4 v3, s[48:51], s5 offen offset:1024 nt lds
  buffer_load_dwordx4 v4, s[48:51], s5 offen offset:2048 nt lds
  buffer_load_dwordx4 v5, s[48:51], s5 offen offset:3072 nt lds
  s_add_u32 s5, s10, 4096
  buffer_load_dwordx4 v[160:163], v6, s[52:55], s10 offen offset:0 nt
  buffer_load_dwordx4 v[164:167], v6, s[52:55], s10 offen offset:1024 nt
  buffer_load_dwordx4 v[168:171], v6, s[52:55], s10 offen offset:2048 nt
  buffer_load_dwordx4 v[172:175], v6, s[52:55], s10 offen offset:3072 nt
  buffer_load_dwordx4 v[176:179], v6, s[52:55], s5 offen offset:0 nt
  buffer_load_dwordx4 v[180:183], v6, s[52:55], s5 offen offset:1024 nt
  buffer_load_dwordx4 v[184:187], v6, s[52:55], s5 offen offset:2048 nt
  buffer_load_dwordx4 v[188:191], v6, s[52:55], s5 offen offset:3072 nt
  s_add_u32 s10, s10, 1835008
  s_add_u32 s5, s10, 4096
  s_add_u32 m0, s101, 8192
  s_nop 0
  buffer_load_dwordx4 v2, s[48:51], s10 offen offset:0 nt lds
  buffer_load_dwordx4 v3, s[48:51], s10 offen offset:1024 nt lds
  buffer_load_dwordx4 v4, s[48:51], s10 offen offset:2048 nt lds
  buffer_load_dwordx4 v5, s[48:51], s10 offen offset:3072 nt lds
  s_add_u32 m0, s101, 12288
  s_nop 0
  buffer_load_dwordx4 v2, s[48:51], s5 offen offset:0 nt lds
  buffer_load_dwordx4 v3, s[48:51], s5 offen offset:1024 nt lds
  buffer_load_dwordx4 v4, s[48:51], s5 offen offset:2048 nt lds
  buffer_load_dwordx4 v5, s[48:51], s5 offen offset:3072 nt lds
  s_add_u32 s5, s10, 4096
  buffer_load_dwordx4 v[192:195], v6, s[52:55], s10 offen offset:0 nt
  buffer_load_dwordx4 v[196:199], v6, s[52:55], s10 offen offset:1024 nt
  buffer_load_dwordx4 v[200:203], v6, s[52:55], s10 offen offset:2048 nt
  buffer_load_dwordx4 v[204:207], v6, s[52:55], s10 offen offset:3072 nt
  buffer_load_dwordx4 v[208:211], v6, s[52:55], s5 offen offset:0 nt
  buffer_load_dwordx4 v[212:215], v6, s[52:55], s5 offen offset:1024 nt
  buffer_load_dwordx4 v[216:219], v6, s[52:55], s5 offen offset:2048 nt
  buffer_load_dwordx4 v[220:223], v6, s[52:55], s5 offen offset:3072 nt
  s_add_u32 s10, s10, 1835008
  s_add_u32 s5, s10, 4096
  s_add_u32 m0, s101, 16384
  s_nop 0
  buffer_load_dwordx4 v2, s[48:51], s10 offen offset:0 nt lds
  buffer_load_dwordx4 v3, s[48:51], s10 offen offset:1024 nt lds
  buffer_load_dwordx4 v4, s[48:51], s10 offen offset:2048 nt lds
  buffer_load_dwordx4 v5, s[48:51], s10 offen offset:3072 nt lds
  s_add_u32 m0, s101, 20480
  s_nop 0
  buffer_load_dwordx4 v2, s[48:51], s5 offen offset:0 nt lds
  buffer_load_dwordx4 v3, s[48:51], s5 offen offset:1024 nt lds
  buffer_load_dwordx4 v4, s[48:51], s5 offen offset:2048 nt lds
  buffer_load_dwordx4 v5, s[48:51], s5 offen offset:3072 nt lds
  s_add_u32 s5, s10, 4096
  buffer_load_dwordx4 v[224:227], v6, s[52:55], s10 offen offset:0 nt
  buffer_load_dwordx4 v[228:231], v6, s[52:55], s10 offen offset:1024 nt
  buffer_load_dwordx4 v[232:235], v6, s[52:55], s10 offen offset:2048 nt
  buffer_load_dwordx4 v[236:239], v6, s[52:55], s10 offen offset:3072 nt
  buffer_load_dwordx4 v[240:243], v6, s[52:55], s5 offen offset:0 nt
  buffer_load_dwordx4 v[244:247], v6, s[52:55], s5 offen offset:1024 nt
  buffer_load_dwordx4 v[248:251], v6, s[52:55], s5 offen offset:2048 nt
  buffer_load_dwordx4 v[252:255], v6, s[52:55], s5 offen offset:3072 nt
  s_add_u32 s10, s10, 1835008
  s_mov_b32 s11, 3
  s_mov_b32 s13, 0
  s_mov_b32 s8, 1000
  s_mul_i32 s4, s3, 96
  s_add_u32 s4, s4, 123520
  v_mov_b32 v60, s4
  s_lshl_b32 s4, s3, 2
  s_add_u32 s4, s4, 123904
  v_mov_b32 v61, s4
  s_barrier
  ds_read_b128 v[16:19], v15 offset:0
  ds_read_b128 v[20:23], v15 offset:64
  ds_read_b128 v[24:27], v15 offset:128
  ds_read_b128 v[28:31], v15 offset:192
  v_mov_b32 v12, 0xff800000
  v_mov_b32 v13, 0
  v_mov_b32 v64, 0
  v_mov_b32 v65, 0
  v_mov_b32 v66, 0
  v_mov_b32 v67, 0
  v_mov_b32 v68, 0
  v_mov_b32 v69, 0
  v_mov_b32 v70, 0
  v_mov_b32 v71, 0
  v_mov_b32 v72, 0
  v_mov_b32 v73, 0
  v_mov_b32 v74, 0
  v_mov_b32 v75, 0
  v_mov_b32 v76, 0
  v_mov_b32 v77, 0
  v_mov_b32 v78, 0
  v_mov_b32 v79, 0
  v_mov_b32 v80, 0
  v_mov_b32 v81, 0
  v_mov_b32 v82, 0
  v_mov_b32 v83, 0
  v_mov_b32 v84, 0
  v_mov_b32 v85, 0
  v_mov_b32 v86, 0
  v_mov_b32 v87, 0
  v_mov_b32 v88, 0
  v_mov_b32 v89, 0
  v_mov_b32 v90, 0
  v_mov_b32 v91, 0
  v_mov_b32 v92, 0
  v_mov_b32 v93, 0
  v_mov_b32 v94, 0
  v_mov_b32 v95, 0
  s_waitcnt lgkmcnt(0)
  s_add_u32 s40, s40, 1
  s_and_b32 s45, s40, 0xff
  s_and_b32 s46, s40, 0xfff
  s_and_b32 s47, s40, 0xffff
  s_mov_b32 s9, 0
L_sloop:
  s_cmp_lt_u32 s11, 5
  s_cbranch_scc1 L_st_11
  s_cmp_eq_u32 s13, 1
  s_cbranch_scc1 L_dn_12
  s_mov_b64 exec, 1
  s_sub_u32 s4, s11, 5
  s_lshl_b32 s4, s4, 2
  v_add_u32 v62, s4, v60
  s_mov_b32 s96, 0
L_mbp_14:
  ds_read_b32 v63, v62
  s_waitcnt lgkmcnt(0)
  v_readfirstlane_b32 s4, v63
  s_cmp_lg_u32 s4, 0xffffffff
  s_cbranch_scc1 L_got_15
  s_sleep 1
  s_add_u32 s96, s96, 1
  s_cmp_lt_u32 s96, 1600000
  s_cbranch_scc1 L_mbp_14
  s_branch L_abort
L_got_15:
  s_sub_u32 s5, s11, 4
  v_mov_b32 v63, s5
  ds_write_b32 v61, v63
  s_mov_b64 exec, -1
  s_mov_b32 s10, s4
  s_cmp_eq_u32 s4, 0x2000000
  s_cbranch_scc0 L_nf_13
  s_mov_b32 s13, 1
  s_mov_b32 s8, s11
  s_branch L_nf_13
L_dn_12:
  s_mov_b32 s10, 0x2000000
  s_branch L_nf_13
L_st_11:
  s_mul_i32 s10, s11, 1835008
  s_add_u32 s10, s10, s12
L_nf_13:
  s_add_u32 s11, s11, 1
  s_waitcnt vmcnt(40)
  ds_read_b128 v[96:99], v7 offset:0
  ds_read_b128 v[100:103], v8 offset:0
  ds_read_b128 v[104:107], v9 offset:0
  ds_read_b128 v[108:111], v10 offset:0
  ds_read_b128 v[112:115], v7 offset:4096
  ds_read_b128 v[116:119], v8 offset:4096
  ds_read_b128 v[120:123], v9 offset:4096
  ds_read_b128 v[124:127], v10 offset:4096
  s_waitcnt lgkmcnt(4)
  v_mfma_f32_16x16x32_bf16 v[32:35], v[96:99], v[16:19], 0
  v_mfma_f32_16x16x32_bf16 v[32:35], v[100:103], v[20:23], v[32:35]
  v_mfma_f32_16x16x32_bf16 v[32:35], v[104:107], v[24:27], v[32:35]
  v_mfma_f32_16x16x32_bf16 v[32:35], v[108:111], v[28:31], v[32:35]
  s_waitcnt lgkmcnt(0)
  v_mfma_f32_16x16x32_bf16 v[36:39], v[112:115], v[16:19], 0
  v_mfma_f32_16x16x32_bf16 v[36:39], v[116:119], v[20:23], v[36:39]
  v_mfma_f32_16x16x32_bf16 v[36:39], v[120:123], v[24:27], v[36:39]
  v_mfma_f32_16x16x32_bf16 v[36:39], v[124:127], v[28:31], v[36:39]
  s_add_u32 s5, s10, 4096
  s_add_u32 m0, s101, 0
  s_nop 0
  buffer_load_dwordx4 v2, s[48:51], s10 offen offset:0 nt lds
  buffer_load_dwordx4 v3, s[48:51], s10 offen offset:1024 nt lds
  buffer_load_dwordx4 v4, s[48:51], s10 offen offset:2048 nt lds
  buffer_load_dwordx4 v5, s[48:51], s10 offen offset:3072 nt lds
  s_add_u32 m0, s101, 4096
  s_nop 0
  buffer_load_dwordx4 v2, s[48:51], s5 offen offset:0 nt lds
  buffer_load_dwordx4 v3, s[48:51], s5 offen offset:1024 nt lds
  buffer_load_dwordx4 v4, s[48:51], s5 offen offset:2048 nt lds
  buffer_load_dwordx4 v5, s[48:51], s5 offen offset:3072 nt lds
  v_cvt_pk_bf16_f32 v52, v32, v33
  v_cvt_pk_bf16_f32 v53, v34, v35
  v_cvt_pk_bf16_f32 v54, v36, v37
  v_cvt_pk_bf16_f32 v55, v38, v39
  v_lshlrev_b32 v40, 16, v52
  v_and_b32 v41, s97, v52
  v_lshlrev_b32 v42, 16, v53
  v_and_b32 v43, s97, v53
  v_lshlrev_b32 v44, 16, v54
  v_and_b32 v45, s97, v54
  v_lshlrev_b32 v46, 16, v55
  v_and_b32 v47, s97, v55
  v_mul_f32 v40, s62, v40
  v_mul_f32 v41, s62, v41
  v_mul_f32 v42, s62, v42
  v_mul_f32 v43, s62, v43
  v_mul_f32 v44, s62, v44
  v_mul_f32 v45, s62, v45
  v_mul_f32 v46, s62, v46
  v_mul_f32 v47, s62, v47
  v_cvt_pk_bf16_f32 v52, v40, v41
  v_cvt_pk_bf16_f32 v53, v42, v43
  v_cvt_pk_bf16_f32 v54, v44, v45
  v_cvt_pk_bf16_f32 v55, v46, v47
  v_lshlrev_b32 v40, 16, v52
  v_and_b32 v41, s97, v52
  v_lshlrev_b32 v42, 16, v53
  v_and_b32 v43, s97, v53
  v_lshlrev_b32 v44, 16, v54
  v_and_b32 v45, s97, v54
  v_lshlrev_b32 v46, 16, v55
  v_and_b32 v47, s97, v55
  v_max3_f32 v52, v40, v41, v42
  v_max3_f32 v53, v43, v44, v45
  v_max3_f32 v52, v52, v46, v47
  v_max3_f32 v52, v52, v53, v12
  v_mov_b32 v53, v52
  s_nop 1
  v_permlane16_swap_b32 v53, v52
  v_max_f32 v52, v52, v53
  v_mov_b32 v53, v52
  s_nop 1
  v_permlane32_swap_b32 v53, v52
  v_max_f32 v52, v52, v53
  v_sub_f32 v53, v12, v52
  v_mul_f32 v53, s63, v53
  v_mul_f32 v11, s63, v52
  v_exp_f32 v14, v53
  v_mov_b32 v12, v52
  v_fma_f32 v40, v40, s63, -v11
  v_fma_f32 v41, v41, s63, -v11
  v_fma_f32 v42, v42, s63, -v11
  v_fma_f32 v43, v43, s63, -v11
  v_fma_f32 v44, v44, s63, -v11
  v_fma_f32 v45, v45, s63, -v11
  v_fma_f32 v46, v46, s63, -v11
  v_fma_f32 v47, v47, s63, -v11
  v_exp_f32 v40, v40
  v_exp_f32 v41, v41
  v_exp_f32 v42, v42
  v_exp_f32 v43, v43
  v_exp_f32 v44, v44
  v_exp_f32 v45, v45
  v_exp_f32 v46, v46
  v_exp_f32 v47, v47
  v_add_f32 v52, v40, v41
  v_add_f32 v53, v42, v43
  v_add_f32 v54, v44, v45
  v_add_f32 v55, v46, v47
  v_add_f32 v52, v52, v53
  v_add_f32 v54, v54, v55
  v_add_f32 v52, v52, v54
  v_fma_f32 v13, v13, v14, v52
  v_cvt_pk_bf16_f32 v48, v40, v41
  v_cvt_pk_bf16_f32 v49, v42, v43
  v_cvt_pk_bf16_f32 v50, v44, v45
  v_cvt_pk_bf16_f32 v51, v46, v47
  v_pk_mul_f32 v[64:65], v[64:65], v[14:15] op_sel_hi:[1,0]
  v_pk_mul_f32 v[66:67], v[66:67], v[14:15] op_sel_hi:[1,0]
  v_pk_mul_f32 v[68:69], v[68:69], v[14:15] op_sel_hi:[1,0]
  v_pk_mul_f32 v[70:71], v[70:71], v[14:15] op_sel_hi:[1,0]
  v_pk_mul_f32 v[72:73], v[72:73], v[14:15] op_sel_hi:[1,0]
  v_pk_mul_f32 v[74:75], v[74:75], v[14:15] op_sel_hi:[1,0]
  v_pk_mul_f32 v[76:77], v[76:77], v[14:15] op_sel_hi:[1,0]
  v_pk_mul_f32 v[78:79], v[78:79], v[14:15] op_sel_hi:[1,0]
  v_pk_mul_f32 v[80:81], v[80:81], v[14:15] op_sel_hi:[1,0]
  v_pk_mul_f32 v[82:83], v[82:83], v[14:15] op_sel_hi:[1,0]
  v_pk_mul_f32 v[84:85], v[84:85], v[14:15] op_sel_hi:[1,0]
  v_pk_mul_f32 v[86:87], v[86:87], v[14:15] op_sel_hi:[1,0]
  v_pk_mul_f32 v[88:89], v[88:89], v[14:15] op_sel_hi:[1,0]
  v_pk_mul_f32 v[90:91], v[90:91], v[14:15] op_sel_hi:[1,0]
  v_pk_mul_f32 v[92:93], v[92:93], v[14:15] op_sel_hi:[1,0]
  v_pk_mul_f32 v[94:95], v[94:95], v[14:15] op_sel_hi:[1,0]
  s_waitcnt vmcnt(40)
  v_perm_b32 v128, v164, v160, s60
  v_perm_b32 v129, v172, v168, s60
  v_perm_b32 v130, v180, v176, s60
  v_perm_b32 v131, v188, v184, s60
  v_perm_b32 v132, v164, v160, s61
  v_perm_b32 v133, v172, v168, s61
  v_perm_b32 v134, v180, v176, s61
  v_perm_b32 v135, v188, v184, s61
  v_perm_b32 v136, v165, v161, s60
  v_perm_b32 v137, v173, v169, s60
  v_perm_b32 v138, v181, v177, s60
  v_perm_b32 v139, v189, v185, s60
  v_perm_b32 v140, v165, v161, s61
  v_perm_b32 v141, v173, v169, s61
  v_perm_b32 v142, v181, v177, s61
  v_perm_b32 v143, v189, v185, s61
  v_perm_b32 v144, v166, v162, s60
  v_perm_b32 v145, v174, v170, s60
  v_perm_b32 v146, v182, v178, s60
  v_perm_b32 v147, v190, v186, s60
  v_perm_b32 v148, v166, v162, s61
  v_perm_b32 v149, v174, v170, s61
  v_perm_b32 v150, v182, v178, s61
  v_perm_b32 v151, v190, v186, s61
  v_perm_b32 v152, v167, v163, s60
  v_perm_b32 v153, v175, v171, s60
  v_perm_b32 v154, v183, v179, s60
  v_perm_b32 v155, v191, v187, s60
  v_perm_b32 v156, v167, v163, s61
  v_perm_b32 v157, v175, v171, s61
  v_perm_b32 v158, v183, v179, s61
  v_perm_b32 v159, v191, v187, s61
  v_mfma_f32_16x16x32_bf16 v[64:67], v[128:131], v[48:51], v[64:67]
  v_mfma_f32_16x16x32_bf16 v[68:71], v[132:135], v[48:51], v[68:71]
  v_mfma_f32_16x16x32_bf16 v[72:75], v[136:139], v[48:51], v[72:75]
  v_mfma_f32_16x16x32_bf16 v[76:79], v[140:143], v[48:51], v[76:79]
  v_mfma_f32_16x16x32_bf16 v[80:83], v[144:147], v[48:51], v[80:83]
  v_mfma_f32_16x16x32_bf16 v[84:87], v[148:151], v[48:51], v[84:87]
  v_mfma_f32_16x16x32_bf16 v[88:91], v[152:155], v[48:51], v[88:91]
  v_mfma_f32_16x16x32_bf16 v[92:95], v[156:159], v[48:51], v[92:95]
  s_add_u32 s5, s10, 4096
  buffer_load_dwordx4 v[160:163], v6, s[52:55], s10 offen offset:0 nt
  buffer_load_dwordx4 v[164:167], v6, s[52:55], s10 offen offset:1024 nt
  buffer_load_dwordx4 v[168:171], v6, s[52:55], s10 offen offset:2048 nt
  buffer_load_dwordx4 v[172:175], v6, s[52:55], s10 offen offset:3072 nt
  buffer_load_dwordx4 v[176:179], v6, s[52:55], s5 offen offset:0 nt
  buffer_load_dwordx4 v[180:183], v6, s[52:55], s5 offen offset:1024 nt
  buffer_load_dwordx4 v[184:187], v6, s[52:55], s5 offen offset:2048 nt
  buffer_load_dwordx4 v[188:191], v6, s[52:55], s5 offen offset:3072 nt
  s_add_u32 s9, s9, 1
  s_cmp_ge_u32 s9, s8
  s_cbranch_scc1 L_sdone
  s_cmp_lt_u32 s11, 5
  s_cbranch_scc1 L_st_16
  s_cmp_eq_u32 s13, 1
  s_cbranch_scc1 L_dn_17
  s_mov_b64 exec, 1
  s_sub_u32 s4, s11, 5
  s_lshl_b32 s4, s4, 2
  v_add_u32 v62, s4, v60
  s_mov_b32 s96, 0
L_mbp_19:
  ds_read_b32 v63, v62
  s_waitcnt lgkmcnt(0)
  v_readfirstlane_b32 s4, v63
  s_cmp_lg_u32 s4, 0xffffffff
  s_cbranch_scc1 L_got_20
  s_sleep 1
  s_add_u32 s96, s96, 1
  s_cmp_lt_u32 s96, 1600000
  s_cbranch_scc1 L_mbp_19
  s_branch L_abort
L_got_20:
  s_sub_u32 s5, s11, 4
  v_mov_b32 v63, s5
  ds_write_b32 v61, v63
  s_mov_b64 exec, -1
  s_mov_b32 s10, s4
  s_cmp_eq_u32 s4, 0x2000000
  s_cbranch_scc0 L_nf_18
  s_mov_b32 s13, 1
  s_mov_b32 s8, s11
  s_branch L_nf_18
L_dn_17:
  s_mov_b32 s10, 0x2000000
  s_branch L_nf_18
L_st_16:
  s_mul_i32 s10, s11, 1835008
  s_add_u32 s10, s10, s12
L_nf_18:
  s_add_u32 s11, s11, 1
  s_waitcnt vmcnt(40)
  ds_read_b128 v[96:99], v7 offset:8192
  ds_read_b128 v[100:103], v8 offset:8192
  ds_read_b128 v[104:107], v9 offset:8192
  ds_read_b128 v[108:111], v10 offset:8192
  ds_read_b128 v[112:115], v7 offset:12288
  ds_read_b128 v[116:119], v8 offset:12288
  ds_read_b128 v[120:123], v9 offset:12288
  ds_read_b128 v[124:127], v10 offset:12288
  s_waitcnt lgkmcnt(4)
  v_mfma_f32_16x16x32_bf16 v[32:35], v[96:99], v[16:19], 0
  v_mfma_f32_16x16x32_bf16 v[32:35], v[100:103], v[20:23], v[32:35]
  v_mfma_f32_16x16x32_bf16 v[32:35], v[104:107], v[24:27], v[32:35]
  v_mfma_f32_16x16x32_bf16 v[32:35], v[108:111], v[28:31], v[32:35]
  s_waitcnt lgkmcnt(0)
  v_mfma_f32_16x16x32_bf16 v[36:39], v[112:115], v[16:19], 0
  v_mfma_f32_16x16x32_bf16 v[36:39], v[116:119], v[20:23], v[36:39]
  v_mfma_f32_16x16x32_bf16 v[36:39], v[120:123], v[24:27], v[36:39]
  v_mfma_f32_16x16x32_bf16 v[36:39], v[124:127], v[28:31], v[36:39]
  s_add_u32 s5, s10, 4096
  s_add_u32 m0, s101, 8192
  s_nop 0
  buffer_load_dwordx4 v2, s[48:51], s10 offen offset:0 nt lds
  buffer_load_dwordx4 v3, s[48:51], s10 offen offset:1024 nt lds
  buffer_load_dwordx4 v4, s[48:51], s10 offen offset:2048 nt lds
  buffer_load_dwordx4 v5, s[48:51], s10 offen offset:3072 nt lds
  s_add_u32 m0, s101, 12288
  s_nop 0
  buffer_load_dwordx4 v2, s[48:51], s5 offen offset:0 nt lds
  buffer_load_dwordx4 v3, s[48:51], s5 offen offset:1024 nt lds
  buffer_load_dwordx4 v4, s[48:51], s5 offen offset:2048 nt lds
  buffer_load_dwordx4 v5, s[48:51], s5 offen offset:3072 nt lds
  v_cvt_pk_bf16_f32 v52, v32, v33
  v_cvt_pk_bf16_f32 v53, v34, v35
  v_cvt_pk_bf16_f32 v54, v36, v37
  v_cvt_pk_bf16_f32 v55, v38, v39
  v_lshlrev_b32 v40, 16, v52
  v_and_b32 v41, s97, v52
  v_lshlrev_b32 v42, 16, v53
  v_and_b32 v43, s97, v53
  v_lshlrev_b32 v44, 16, v54
  v_and_b32 v45, s97, v54
  v_lshlrev_b32 v46, 16, v55
  v_and_b32 v47, s97, v55
  v_mul_f32 v40, s62, v40
  v_mul_f32 v41, s62, v41
  v_mul_f32 v42, s62, v42
  v_mul_f32 v43, s62, v43
  v_mul_f32 v44, s62, v44
  v_mul_f32 v45, s62, v45
  v_mul_f32 v46, s62, v46
  v_mul_f32 v47, s62, v47
  v_cvt_pk_bf16_f32 v52, v40, v41
  v_cvt_pk_bf16_f32 v53, v42, v43
  v_cvt_pk_bf16_f32 v54, v44, v45
  v_cvt_pk_bf16_f32 v55, v46, v47
  v_lshlrev_b32 v40, 16, v52
  v_and_b32 v41, s97, v52
  v_lshlrev_b32 v42, 16, v53
  v_and_b32 v43, s97, v53
  v_lshlrev_b32 v44, 16, v54
  v_and_b32 v45, s97, v54
  v_lshlrev_b32 v46, 16, v55
  v_and_b32 v47, s97, v55
  v_max3_f32 v52, v40, v41, v42
  v_max3_f32 v53, v43, v44, v45
  v_max3_f32 v52, v52, v46, v47
  v_max3_f32 v52, v52, v53, v12
  v_mov_b32 v53, v52
  s_nop 1
  v_permlane16_swap_b32 v53, v52
  v_max_f32 v52, v52, v53
  v_mov_b32 v53, v52
  s_nop 1
  v_permlane32_swap_b32 v53, v52
  v_max_f32 v52, v52, v53
  v_sub_f32 v53, v12, v52
  v_mul_f32 v53, s63, v53
  v_mul_f32 v11, s63, v52
  v_exp_f32 v14, v53
  v_mov_b32 v12, v52
  v_fma_f32 v40, v40, s63, -v11
  v_fma_f32 v41, v41, s63, -v11
  v_fma_f32 v42, v42, s63, -v11
  v_fma_f32 v43, v43, s63, -v11
  v_fma_f32 v44, v44, s63, -v11
  v_fma_f32 v45, v45, s63, -v11
  v_fma_f32 v46, v46, s63, -v11
  v_fma_f32 v47, v47, s63, -v11
  v_exp_f32 v40, v40
  v_exp_f32 v41, v41
  v_exp_f32 v42, v42
  v_exp_f32 v43, v43
  v_exp_f32 v44, v44
  v_exp_f32 v45, v45
  v_exp_f32 v46, v46
  v_exp_f32 v47, v47
  v_add_f32 v52, v40, v41
  v_add_f32 v53, v42, v43
  v_add_f32 v54, v44, v45
  v_add_f32 v55, v46, v47
  v_add_f32 v52, v52, v53
  v_add_f32 v54, v54, v55
  v_add_f32 v52, v52, v54
  v_fma_f32 v13, v13, v14, v52
  v_cvt_pk_bf16_f32 v48, v40, v41
  v_cvt_pk_bf16_f32 v49, v42, v43
  v_cvt_pk_bf16_f32 v50, v44, v45
  v_cvt_pk_bf16_f32 v51, v46, v47
  v_pk_mul_f32 v[64:65], v[64:65], v[14:15] op_sel_hi:[1,0]
  v_pk_mul_f32 v[66:67], v[66:67], v[14:15] op_sel_hi:[1,0]
  v_pk_mul_f32 v[68:69], v[68:69], v[14:15] op_sel_hi:[1,0]
  v_pk_mul_f32 v[70:71], v[70:71], v[14:15] op_sel_hi:[1,0]
  v_pk_mul_f32 v[72:73], v[72:73], v[14:15] op_sel_hi:[1,0]
  v_pk_mul_f32 v[74:75], v[74:75], v[14:15] op_sel_hi:[1,0]
  v_pk_mul_f32 v[76:77], v[76:77], v[14:15] op_sel_hi:[1,0]
  v_pk_mul_f32 v[78:79], v[78:79], v[14:15] op_sel_hi:[1,0]
  v_pk_mul_f32 v[80:81], v[80:81], v[14:15] op_sel_hi:[1,0]
  v_pk_mul_f32 v[82:83], v[82:83], v[14:15] op_sel_hi:[1,0]
  v_pk_mul_f32 v[84:85], v[84:85], v[14:15] op_sel_hi:[1,0]
  v_pk_mul_f32 v[86:87], v[86:87], v[14:15] op_sel_hi:[1,0]
  v_pk_mul_f32 v[88:89], v[88:89], v[14:15] op_sel_hi:[1,0]
  v_pk_mul_f32 v[90:91], v[90:91], v[14:15] op_sel_hi:[1,0]
  v_pk_mul_f32 v[92:93], v[92:93], v[14:15] op_sel_hi:[1,0]
  v_pk_mul_f32 v[94:95], v[94:95], v[14:15] op_sel_hi:[1,0]
  s_waitcnt vmcnt(40)
  v_perm_b32 v128, v196, v192, s60
  v_perm_b32 v129, v204, v200, s60
  v_perm_b32 v130, v212, v208, s60
  v_perm_b32 v131, v220, v216, s60
  v_perm_b32 v132, v196, v192, s61
  v_perm_b32 v133, v204, v200, s61
  v_perm_b32 v134, v212, v208, s61
  v_perm_b32 v135, v220, v216, s61
  v_perm_b32 v136, v197, v193, s60
  v_perm_b32 v137, v205, v201, s60
  v_perm_b32 v138, v213, v209, s60
  v_perm_b32 v139, v221, v217, s60
  v_perm_b32 v140, v197, v193, s61
  v_perm_b32 v141, v205, v201, s61
  v_perm_b32 v142, v213, v209, s61
  v_perm_b32 v143, v221, v217, s61
  v_perm_b32 v144, v198, v194, s60
  v_perm_b32 v145, v206, v202, s60
  v_perm_b32 v146, v214, v210, s60
  v_perm_b32 v147, v222, v218, s60
  v_perm_b32 v148, v198, v194, s61
  v_perm_b32 v149, v206, v202, s61
  v_perm_b32 v150, v214, v210, s61
  v_perm_b32 v151, v222, v218, s61
  v_perm_b32 v152, v199, v195, s60
  v_perm_b32 v153, v207, v203, s60
  v_perm_b32 v154, v215, v211, s60
  v_perm_b32 v155, v223, v219, s60
  v_perm_b32 v156, v199, v195, s61
  v_perm_b32 v157, v207, v203, s61
  v_perm_b32 v158, v215, v211, s61
  v_perm_b32 v159, v223, v219, s61
  v_mfma_f32_16x16x32_bf16 v[64:67], v[128:131], v[48:51], v[64:67]
  v_mfma_f32_16x16x32_bf16 v[68:71], v[132:135], v[48:51], v[68:71]
  v_mfma_f32_16x16x32_bf16 v[72:75], v[136:139], v[48:51], v[72:75]
  v_mfma_f32_16x16x32_bf16 v[76:79], v[140:143], v[48:51], v[76:79]
  v_mfma_f32_16x16x32_bf16 v[80:83], v[144:147], v[48:51], v[80:83]
  v_mfma_f32_16x16x32_bf16 v[84:87], v[148:151], v[48:51], v[84:87]
  v_mfma_f32_16x16x32_bf16 v[88:91], v[152:155], v[48:51], v[88:91]
  v_mfma_f32_16x16x32_bf16 v[92:95], v[156:159], v[48:51], v[92:95]
  s_add_u32 s5, s10, 4096
  buffer_load_dwordx4 v[192:195], v6, s[52:55], s10 offen offset:0 nt
  buffer_load_dwordx4 v[196:199], v6, s[52:55], s10 offen offset:1024 nt
  buffer_load_dwordx4 v[200:203], v6, s[52:55], s10 offen offset:2048 nt
  buffer_load_dwordx4 v[204:207], v6, s[52:55], s10 offen offset:3072 nt
  buffer_load_dwordx4 v[208:211], v6, s[52:55], s5 offen offset:0 nt
  buffer_load_dwordx4 v[212:215], v6, s[52:55], s5 offen offset:1024 nt
  buffer_load_dwordx4 v[216:219], v6, s[52:55], s5 offen offset:2048 nt
  buffer_load_dwordx4 v[220:223], v6, s[52:55], s5 offen offset:3072 nt
  s_add_u32 s9, s9, 1
  s_cmp_ge_u32 s9, s8
  s_cbranch_scc1 L_sdone
  s_cmp_lt_u32 s11, 5
  s_cbranch_scc1 L_st_21
  s_cmp_eq_u32 s13, 1
  s_cbranch_scc1 L_dn_22
  s_mov_b64 exec, 1
  s_sub_u32 s4, s11, 5
  s_lshl_b32 s4, s4, 2
  v_add_u32 v62, s4, v60
  s_mov_b32 s96, 0
L_mbp_24:
  ds_read_b32 v63, v62
  s_waitcnt lgkmcnt(0)
  v_readfirstlane_b32 s4, v63
  s_cmp_lg_u32 s4, 0xffffffff
  s_cbranch_scc1 L_got_25
  s_sleep 1
  s_add_u32 s96, s96, 1
  s_cmp_lt_u32 s96, 1600000
  s_cbranch_scc1 L_mbp_24
  s_branch L_abort
L_got_25:
  s_sub_u32 s5, s11, 4
  v_mov_b32 v63, s5
  ds_write_b32 v61, v63
  s_mov_b64 exec, -1
  s_mov_b32 s10, s4
  s_cmp_eq_u32 s4, 0x2000000
  s_cbranch_scc0 L_nf_23
  s_mov_b32 s13, 1
  s_mov_b32 s8, s11
  s_branch L_nf_23
L_dn_22:
  s_mov_b32 s10, 0x2000000
  s_branch L_nf_23
L_st_21:
  s_mul_i32 s10, s11, 1835008
  s_add_u32 s10, s10, s12
L_nf_23:
  s_add_u32 s11, s11, 1
  s_waitcnt vmcnt(40)
  ds_read_b128 v[96:99], v7 offset:16384
  ds_read_b128 v[100:103], v8 offset:16384
  ds_read_b128 v[104:107], v9 offset:16384
  ds_read_b128 v[108:111], v10 offset:16384
  ds_read_b128 v[112:115], v7 offset:20480
  ds_read_b128 v[116:119], v8 offset:20480
  ds_read_b128 v[120:123], v9 offset:20480
  ds_read_b128 v[124:127], v10 offset:20480
  s_waitcnt lgkmcnt(4)
  v_mfma_f32_16x16x32_bf16 v[32:35], v[96:99], v[16:19], 0
  v_mfma_f32_16x16x32_bf16 v[32:35], v[100:103], v[20:23], v[32:35]
  v_mfma_f32_16x16x32_bf16 v[32:35], v[104:107], v[24:27], v[32:35]
  v_mfma_f32_16x16x32_bf16 v[32:35], v[108:111], v[28:31], v[32:35]
  s_waitcnt lgkmcnt(0)
  v_mfma_f32_16x16x32_bf16 v[36:39], v[112:115], v[16:19], 0
  v_mfma_f32_16x16x32_bf16 v[36:39], v[116:119], v[20:23], v[36:39]
  v_mfma_f32_16x16x32_bf16 v[36:39], v[120:123], v[24:27], v[36:39]
  v_mfma_f32_16x16x32_bf16 v[36:39], v[124:127], v[28:31], v[36:39]
  s_add_u32 s5, s10, 4096
  s_add_u32 m0, s101, 16384
  s_nop 0
  buffer_load_dwordx4 v2, s[48:51], s10 offen offset:0 nt lds
  buffer_load_dwordx4 v3, s[48:51], s10 offen offset:1024 nt lds
  buffer_load_dwordx4 v4, s[48:51], s10 offen offset:2048 nt lds
  buffer_load_dwordx4 v5, s[48:51], s10 offen offset:3072 nt lds
  s_add_u32 m0, s101, 20480
  s_nop 0
  buffer_load_dwordx4 v2, s[48:51], s5 offen offset:0 nt lds
  buffer_load_dwordx4 v3, s[48:51], s5 offen offset:1024 nt lds
  buffer_load_dwordx4 v4, s[48:51], s5 offen offset:2048 nt lds
  buffer_load_dwordx4 v5, s[48:51], s5 offen offset:3072 nt lds
  v_cvt_pk_bf16_f32 v52, v32, v33
  v_cvt_pk_bf16_f32 v53, v34, v35
  v_cvt_pk_bf16_f32 v54, v36, v37
  v_cvt_pk_bf16_f32 v55, v38, v39
  v_lshlrev_b32 v40, 16, v52
  v_and_b32 v41, s97, v52
  v_lshlrev_b32 v42, 16, v53
  v_and_b32 v43, s97, v53
  v_lshlrev_b32 v44, 16, v54
  v_and_b32 v45, s97, v54
  v_lshlrev_b32 v46, 16, v55
  v_and_b32 v47, s97, v55
  v_mul_f32 v40, s62, v40
  v_mul_f32 v41, s62, v41
  v_mul_f32 v42, s62, v42
  v_mul_f32 v43, s62, v43
  v_mul_f32 v44, s62, v44
  v_mul_f32 v45, s62, v45
  v_mul_f32 v46, s62, v46
  v_mul_f32 v47, s62, v47
  v_cvt_pk_bf16_f32 v52, v40, v41
  v_cvt_pk_bf16_f32 v53, v42, v43
  v_cvt_pk_bf16_f32 v54, v44, v45
  v_cvt_pk_bf16_f32 v55, v46, v47
  v_lshlrev_b32 v40, 16, v52
  v_and_b32 v41, s97, v52
  v_lshlrev_b32 v42, 16, v53
  v_and_b32 v43, s97, v53
  v_lshlrev_b32 v44, 16, v54
  v_and_b32 v45, s97, v54
  v_lshlrev_b32 v46, 16, v55
  v_and_b32 v47, s97, v55
  v_max3_f32 v52, v40, v41, v42
  v_max3_f32 v53, v43, v44, v45
  v_max3_f32 v52, v52, v46, v47
  v_max3_f32 v52, v52, v53, v12
  v_mov_b32 v53, v52
  s_nop 1
  v_permlane16_swap_b32 v53, v52
  v_max_f32 v52, v52, v53
  v_mov_b32 v53, v52
  s_nop 1
  v_permlane32_swap_b32 v53, v52
  v_max_f32 v52, v52, v53
  v_sub_f32 v53, v12, v52
  v_mul_f32 v53, s63, v53
  v_mul_f32 v11, s63, v52
  v_exp_f32 v14, v53
  v_mov_b32 v12, v52
  v_fma_f32 v40, v40, s63, -v11
  v_fma_f32 v41, v41, s63, -v11
  v_fma_f32 v42, v42, s63, -v11
  v_fma_f32 v43, v43, s63, -v11
  v_fma_f32 v44, v44, s63, -v11
  v_fma_f32 v45, v45, s63, -v11
  v_fma_f32 v46, v46, s63, -v11
  v_fma_f32 v47, v47, s63, -v11
  v_exp_f32 v40, v40
  v_exp_f32 v41, v41
  v_exp_f32 v42, v42
  v_exp_f32 v43, v43
  v_exp_f32 v44, v44
  v_exp_f32 v45, v45
  v_exp_f32 v46, v46
  v_exp_f32 v47, v47
  v_add_f32 v52, v40, v41
  v_add_f32 v53, v42, v43
  v_add_f32 v54, v44, v45
  v_add_f32 v55, v46, v47
  v_add_f32 v52, v52, v53
  v_add_f32 v54, v54, v55
  v_add_f32 v52, v52, v54
  v_fma_f32 v13, v13, v14, v52
  v_cvt_pk_bf16_f32 v48, v40, v41
  v_cvt_pk_bf16_f32 v49, v42, v43
  v_cvt_pk_bf16_f32 v50, v44, v45
  v_cvt_pk_bf16_f32 v51, v46, v47
  v_pk_mul_f32 v[64:65], v[64:65], v[14:15] op_sel_hi:[1,0]
  v_pk_mul_f32 v[66:67], v[66:67], v[14:15] op_sel_hi:[1,0]
  v_pk_mul_f32 v[68:69], v[68:69], v[14:15] op_sel_hi:[1,0]
  v_pk_mul_f32 v[70:71], v[70:71], v[14:15] op_sel_hi:[1,0]
  v_pk_mul_f32 v[72:73], v[72:73], v[14:15] op_sel_hi:[1,0]
  v_pk_mul_f32 v[74:75], v[74:75], v[14:15] op_sel_hi:[1,0]
  v_pk_mul_f32 v[76:77], v[76:77], v[14:15] op_sel_hi:[1,0]
  v_pk_mul_f32 v[78:79], v[78:79], v[14:15] op_sel_hi:[1,0]
  v_pk_mul_f32 v[80:81], v[80:81], v[14:15] op_sel_hi:[1,0]
  v_pk_mul_f32 v[82:83], v[82:83], v[14:15] op_sel_hi:[1,0]
  v_pk_mul_f32 v[84:85], v[84:85], v[14:15] op_sel_hi:[1,0]
  v_pk_mul_f32 v[86:87], v[86:87], v[14:15] op_sel_hi:[1,0]
  v_pk_mul_f32 v[88:89], v[88:89], v[14:15] op_sel_hi:[1,0]
  v_pk_mul_f32 v[90:91], v[90:91], v[14:15] op_sel_hi:[1,0]
  v_pk_mul_f32 v[92:93], v[92:93], v[14:15] op_sel_hi:[1,0]
  v_pk_mul_f32 v[94:95], v[94:95], v[14:15] op_sel_hi:[1,0]
  s_waitcnt vmcnt(40)
  v_perm_b32 v128, v228, v224, s60
  v_perm_b32 v129, v236, v232, s60
  v_perm_b32 v130, v244, v240, s60
  v_perm_b32 v131, v252, v248, s60
  v_perm_b32 v132, v228, v224, s61
  v_perm_b32 v133, v236, v232, s61
  v_perm_b32 v134, v244, v240, s61
  v_perm_b32 v135, v252, v248, s61
  v_perm_b32 v136, v229, v225, s60
  v_perm_b32 v137, v237, v233, s60
  v_perm_b32 v138, v245, v241, s60
  v_perm_b32 v139, v253, v249, s60
  v_perm_b32 v140, v229, v225, s61
  v_perm_b32 v141, v237, v233, s61
  v_perm_b32 v142, v245, v241, s61
  v_perm_b32 v143, v253, v249, s61
  v_perm_b32 v144, v230, v226, s60
  v_perm_b32 v145, v238, v234, s60
  v_perm_b32 v146, v246, v242, s60
  v_perm_b32 v147, v254, v250, s60
  v_perm_b32 v148, v230, v226, s61
  v_perm_b32 v149, v238, v234, s61
  v_perm_b32 v150, v246, v242, s61
  v_perm_b32 v151, v254, v250, s61
  v_perm_b32 v152, v231, v227, s60
  v_perm_b32 v153, v239, v235, s60
  v_perm_b32 v154, v247, v243, s60
  v_perm_b32 v155, v255, v251, s60
  v_perm_b32 v156, v231, v227, s61
  v_perm_b32 v157, v239, v235, s61
  v_perm_b32 v158, v247, v243, s61
  v_perm_b32 v159, v255, v251, s61
  v_mfma_f32_16x16x32_bf16 v[64:67], v[128:131], v[48:51], v[64:67]
  v_mfma_f32_16x16x32_bf16 v[68:71], v[132:135], v[48:51], v[68:71]
  v_mfma_f32_16x16x32_bf16 v[72:75], v[136:139], v[48:51], v[72:75]
  v_mfma_f32_16x16x32_bf16 v[76:79], v[140:143], v[48:51], v[76:79]
  v_mfma_f32_16x16x32_bf16 v[80:83], v[144:147], v[48:51], v[80:83]
  v_mfma_f32_16x16x32_bf16 v[84:87], v[148:151], v[48:51], v[84:87]
  v_mfma_f32_16x16x32_bf16 v[88:91], v[152:155], v[48:51], v[88:91]
  v_mfma_f32_16x16x32_bf16 v[92:95], v[156:159], v[48:51], v[92:95]
  s_add_u32 s5, s10, 4096
  buffer_load_dwordx4 v[224:227], v6, s[52:55], s10 offen offset:0 nt
  buffer_load_dwordx4 v[228:231], v6, s[52:55], s10 offen offset:1024 nt
  buffer_load_dwordx4 v[232:235], v6, s[52:55], s10 offen offset:2048 nt
  buffer_load_dwordx4 v[236:239], v6, s[52:55], s10 offen offset:3072 nt
  buffer_load_dwordx4 v[240:243], v6, s[52:55], s5 offen offset:0 nt
  buffer_load_dwordx4 v[244:247], v6, s[52:55], s5 offen offset:1024 nt
  buffer_load_dwordx4 v[248:251], v6, s[52:55], s5 offen offset:2048 nt
  buffer_load_dwordx4 v[252:255], v6, s[52:55], s5 offen offset:3072 nt
  s_add_u32 s9, s9, 1
  s_cmp_ge_u32 s9, s8
  s_cbranch_scc0 L_sloop
L_sdone:
  s_nop 7
  v_mov_b32 v53, v13
  s_nop 1
  v_permlane16_swap_b32 v53, v13
  v_add_f32 v13, v13, v53
  v_mov_b32 v53, v13
  s_nop 1
  v_permlane32_swap_b32 v53, v13
  v_add_f32 v13, v13, v53
  v_and_b32 v52, 8, v0
  v_cmp_eq_u32 vcc, 0, v52
  s_and_saveexec_b64 s[4:5], vcc
  s_nop 7
  ds_write_b128 v1, v[64:67] offset:0
  ds_write_b128 v1, v[68:71] offset:16
  ds_write_b128 v1, v[72:75] offset:32
  ds_write_b128 v1, v[76:79] offset:48
  ds_write_b128 v1, v[80:83] offset:64
  ds_write_b128 v1, v[84:87] offset:80
  ds_write_b128 v1, v[88:91] offset:96
  ds_write_b128 v1, v[92:95] offset:112
  s_mov_b64 exec, 0xff
  s_mul_i32 s6, s3, 4288
  s_add_u32 s6, s6, 105664
  v_lshlrev_b32 v52, 3, v0
  v_add_u32 v52, s6, v52
  ds_write_b64 v52, v[12:13]
  s_mov_b64 exec, -1
  s_waitcnt lgkmcnt(0)
  s_barrier
  s_waitcnt vmcnt(0)
  s_barrier
  s_mov_b32 s5, s14
  buffer_load_dwordx4 v[160:163], v56, s[56:59], s5 offen nt
  s_add_u32 s5, s5, 7168
  buffer_load_dwordx4 v[164:167], v56, s[56:59], s5 offen nt
  s_add_u32 s5, s5, 7168
  buffer_load_dwordx4 v[168:171], v56, s[56:59], s5 offen nt
  s_add_u32 s5, s5, 7168
  buffer_load_dwordx4 v[172:175], v56, s[56:59], s5 offen nt
  s_add_u32 s5, s5, 7168
  buffer_load_dwordx4 v[176:179], v56, s[56:59], s5 offen nt
  s_add_u32 s5, s5, 7168
  buffer_load_dwordx4 v[180:183], v56, s[56:59], s5 offen nt
  s_add_u32 s5, s5, 7168
  buffer_load_dwordx4 v[184:187], v56, s[56:59], s5 offen nt
  s_add_u32 s5, s5, 7168
  buffer_load_dwordx4 v[188:191], v56, s[56:59], s5 offen nt
  s_mov_b32 s56, s30
  s_and_b32 s57, s31, 0xffff
  s_mov_b32 s5, s14
  buffer_load_dwordx4 v[192:195], v56, s[56:59], s5 offen nt
  s_add_u32 s5, s5, 7168
  buffer_load_dwordx4 v[196:199], v56, s[56:59], s5 offen nt
  s_add_u32 s5, s5, 7168
  buffer_load_dwordx4 v[200:203], v56, s[56:59], s5 offen nt
  s_add_u32 s5, s5, 7168
  buffer_load_dwordx4 v[204:207], v56, s[56:59], s5 offen nt
  s_add_u32 s5, s5, 7168
  buffer_load_dwordx4 v[208:211], v56, s[56:59], s5 offen nt
  s_add_u32 s5, s5, 7168
  buffer_load_dwordx4 v[212:215], v56, s[56:59], s5 offen nt
  s_add_u32 s5, s5, 7168
  buffer_load_dwordx4 v[216:219], v56, s[56:59], s5 offen nt
  s_add_u32 s5, s5, 7168
  buffer_load_dwordx4 v[220:223], v56, s[56:59], s5 offen nt
  s_lshl_b32 s6, s100, 8
  s_lshl_b32 s7, s3, 6
  s_add_u32 s6, s6, s7
  v_and_b32 v5, 7, v0
  v_lshlrev_b32 v5, 5, v5
  v_lshrrev_b32 v6, 5, v0
  v_lshl_add_u32 v5, v6, 8, v5
  v_bfe_u32 v6, v0, 4, 1
  v_lshl_add_u32 v5, v6, 4, v5
  s_mul_i32 s8, s3, 1088
  s_add_u32 s8, s8, 118592
  v_add_u32 v5, s8, v5
  v_lshlrev_b32 v2, 4, v0
  s_and_b32 s8, s2, 7
  s_lshl_b32 s8, s8, 12
  s_add_u32 s8, s8, 2523136
  v_add_u32 v4, s8, v2
  v_lshrrev_b32 v6, 3, v0
  v_lshlrev_b32 v6, 5, v6
  s_lshl_b32 s9, s6, 2
  s_add_u32 s8, s8, s9
  v_add_u32 v6, s8, v6
  v_mov_b32 v7, s47
  s_mov_b32 s9, 0xffff
  s_waitcnt vmcnt(8)
  v_perm_b32 v64, v164, v160, s60
  v_perm_b32 v68, v164, v160, s61
  v_perm_b32 v65, v165, v161, s60
  v_perm_b32 v69, v165, v161, s61
  v_perm_b32 v66, v166, v162, s60
  v_perm_b32 v70, v166, v162, s61
  v_perm_b32 v67, v167, v163, s60
  v_perm_b32 v71, v167, v163, s61
  v_perm_b32 v72, v172, v168, s60
  v_perm_b32 v76, v172, v168, s61
  v_perm_b32 v73, v173, v169, s60
  v_perm_b32 v77, v173, v169, s61
  v_perm_b32 v74, v174, v170, s60
  v_perm_b32 v78, v174, v170, s61
  v_perm_b32 v75, v175, v171, s60
  v_perm_b32 v79, v175, v171, s61
  v_perm_b32 v80, v180, v176, s60
  v_perm_b32 v84, v180, v176, s61
  v_perm_b32 v81, v181, v177, s60
  v_perm_b32 v85, v181, v177, s61
  v_perm_b32 v82, v182, v178, s60
  v_perm_b32 v86, v182, v178, s61
  v_perm_b32 v83, v183, v179, s60
  v_perm_b32 v87, v183, v179, s61
  v_perm_b32 v88, v188, v184, s60
  v_perm_b32 v92, v188, v184, s61
  v_perm_b32 v89, v189, v185, s60
  v_perm_b32 v93, v189, v185, s61
  v_perm_b32 v90, v190, v186, s60
  v_perm_b32 v94, v190, v186, s61
  v_perm_b32 v91, v191, v187, s60
  v_perm_b32 v95, v191, v187, s61
  s_waitcnt vmcnt(0)
  s_barrier
  v_perm_b32 v96, v196, v192, s60
  v_perm_b32 v100, v196, v192, s61
  v_perm_b32 v97, v197, v193, s60
  v_perm_b32 v101, v197, v193, s61
  v_perm_b32 v98, v198, v194, s60
  v_perm_b32 v102, v198, v194, s61
  v_perm_b32 v99, v199, v195, s60
  v_perm_b32 v103, v199, v195, s61
  v_perm_b32 v104, v204, v200, s60
  v_perm_b32 v108, v204, v200, s61
  v_perm_b32 v105, v205, v201, s60
  v_perm_b32 v109, v205, v201, s61
  v_perm_b32 v106, v206, v202, s60
  v_perm_b32 v110, v206, v202, s61
  v_perm_b32 v107, v207, v203, s60
  v_perm_b32 v111, v207, v203, s61
  v_perm_b32 v112, v212, v208, s60
  v_perm_b32 v116, v212, v208, s61
  v_perm_b32 v113, v213, v209, s60
  v_perm_b32 v117, v213, v209, s61
  v_perm_b32 v114, v214, v210, s60
  v_perm_b32 v118, v214, v210, s61
  v_perm_b32 v115, v215, v211, s60
  v_perm_b32 v119, v215, v211, s61
  v_perm_b32 v120, v220, v216, s60
  v_perm_b32 v124, v220, v216, s61
  v_perm_b32 v121, v221, v217, s60
  v_perm_b32 v125, v221, v217, s61
  v_perm_b32 v122, v222, v218, s60
  v_perm_b32 v126, v222, v218, s61
  v_perm_b32 v123, v223, v219, s60
  v_perm_b32 v127, v223, v219, s61
  s_mov_b32 s8, 0x3f803f80
  v_dot2_f32_bf16 v16, v64, s8, 0
  v_dot2_f32_bf16 v17, v68, s8, 0
  v_dot2_f32_bf16 v18, v65, s8, 0
  v_dot2_f32_bf16 v19, v69, s8, 0
  v_dot2_f32_bf16 v20, v66, s8, 0
  v_dot2_f32_bf16 v21, v70, s8, 0
  v_dot2_f32_bf16 v22, v67, s8, 0
  v_dot2_f32_bf16 v23, v71, s8, 0
  v_dot2_f32_bf16 v16, v72, s8, v16
  v_dot2_f32_bf16 v17, v76, s8, v17
  v_dot2_f32_bf16 v18, v73, s8, v18
  v_dot2_f32_bf16 v19, v77, s8, v19
  v_dot2_f32_bf16 v20, v74, s8, v20
  v_dot2_f32_bf16 v21, v78, s8, v21
  v_dot2_f32_bf16 v22, v75, s8, v22
  v_dot2_f32_bf16 v23, v79, s8, v23
  v_dot2_f32_bf16 v16, v80, s8, v16
  v_dot2_f32_bf16 v17, v84, s8, v17
  v_dot2_f32_bf16 v18, v81, s8, v18
  v_dot2_f32_bf16 v19, v85, s8, v19
  v_dot2_f32_bf16 v20, v82, s8, v20
  v_dot2_f32_bf16 v21, v86, s8, v21
  v_dot2_f32_bf16 v22, v83, s8, v22
  v_dot2_f32_bf16 v23, v87, s8, v23
  v_dot2_f32_bf16 v16, v88, s8, v16
  v_dot2_f32_bf16 v17, v92, s8, v17
  v_dot2_f32_bf16 v18, v89, s8, v18
  v_dot2_f32_bf16 v19, v93, s8, v19
  v_dot2_f32_bf16 v20, v90, s8, v20
  v_dot2_f32_bf16 v21, v94, s8, v21
  v_dot2_f32_bf16 v22, v91, s8, v22
  v_dot2_f32_bf16 v23, v95, s8, v23
  v_dot2_f32_bf16 v24, v96, s8, 0
  v_dot2_f32_bf16 v25, v100, s8, 0
  v_dot2_f32_bf16 v26, v97, s8, 0
  v_dot2_f32_bf16 v27, v101, s8, 0
  v_dot2_f32_bf16 v28, v98, s8, 0
  v_dot2_f32_bf16 v29, v102, s8, 0
  v_dot2_f32_bf16 v30, v99, s8, 0
  v_dot2_f32_bf16 v31, v103, s8, 0
  v_dot2_f32_bf16 v24, v104, s8, v24
  v_dot2_f32_bf16 v25, v108, s8, v25
  v_dot2_f32_bf16 v26, v105, s8, v26
  v_dot2_f32_bf16 v27, v109, s8, v27
  v_dot2_f32_bf16 v28, v106, s8, v28
  v_dot2_f32_bf16 v29, v110, s8, v29
  v_dot2_f32_bf16 v30, v107, s8, v30
  v_dot2_f32_bf16 v31, v111, s8, v31
  v_dot2_f32_bf16 v24, v112, s8, v24
  v_dot2_f32_bf16 v25, v116, s8, v25
  v_dot2_f32_bf16 v26, v113, s8, v26
  v_dot2_f32_bf16 v27, v117, s8, v27
  v_dot2_f32_bf16 v28, v114, s8, v28
  v_dot2_f32_bf16 v29, v118, s8, v29
  v_dot2_f32_bf16 v30, v115, s8, v30
  v_dot2_f32_bf16 v31, v119, s8, v31
  v_dot2_f32_bf16 v24, v120, s8, v24
  v_dot2_f32_bf16 v25, v124, s8, v25
  v_dot2_f32_bf16 v26, v121, s8, v26
  v_dot2_f32_bf16 v27, v125, s8, v27
  v_dot2_f32_bf16 v28, v122, s8, v28
  v_dot2_f32_bf16 v29, v126, s8, v29
  v_dot2_f32_bf16 v30, v123, s8, v30
  v_dot2_f32_bf16 v31, v127, s8, v31
  v_permlane32_swap_b32 v16, v24
  v_permlane32_swap_b32 v17, v25
  v_permlane32_swap_b32 v18, v26
  v_permlane32_swap_b32 v19, v27
  v_permlane32_swap_b32 v20, v28
  v_permlane32_swap_b32 v21, v29
  v_permlane32_swap_b32 v22, v30
  v_permlane32_swap_b32 v23, v31
  v_add_f32 v16, v16, v24
  v_add_f32 v17, v17, v25
  v_add_f32 v18, v18, v26
  v_add_f32 v19, v19, v27
  v_add_f32 v20, v20, v28
  v_add_f32 v21, v21, v29
  v_add_f32 v22, v22, v30
  v_add_f32 v23, v23, v31
  v_permlane16_swap_b32 v16, v20
  v_permlane16_swap_b32 v17, v21
  v_permlane16_swap_b32 v18, v22
  v_permlane16_swap_b32 v19, v23
  v_add_f32 v16, v16, v20
  v_add_f32 v17, v17, v21
  v_add_f32 v18, v18, v22
  v_add_f32 v19, v19, v23
  v_add_f32_dpp v16, v16, v16 row_ror:8 row_mask:0xf bank_mask:0xf
  v_add_f32_dpp v17, v17, v17 row_ror:8 row_mask:0xf bank_mask:0xf
  v_add_f32_dpp v18, v18, v18 row_ror:8 row_mask:0xf bank_mask:0xf
  v_add_f32_dpp v19, v19, v19 row_ror:8 row_mask:0xf bank_mask:0xf
  s_mov_b32 s12, 0x00ff00ff
  s_mov_b32 s13, 0x00ff00ff
  s_mov_b64 exec, s[12:13]
  ds_write_b128 v5, v[16:19] offset:512
  s_mov_b64 exec, -1
  s_mov_b32 s96, 0
L_mp_26:
  global_load_dwordx4 v[128:131], v4, s[38:39] offset:0 sc1
  global_load_dwordx4 v[132:135], v4, s[38:39] offset:1024 sc1
  global_load_dwordx4 v[136:139], v4, s[38:39] offset:2048 sc1
  global_load_dwordx4 v[140:143], v4, s[38:39] offset:3072 sc1
  global_load_dwordx4 v[36:39], v6, s[38:39] sc1
  global_load_dwordx4 v[40:43], v6, s[38:39] offset:16 sc1
  s_waitcnt vmcnt(0)
  v_xor_b32 v36, v7, v36
  v_xor_b32 v37, v7, v37
  v_xor_b32 v38, v7, v38
  v_xor_b32 v39, v7, v39
  v_xor_b32 v40, v7, v40
  v_xor_b32 v41, v7, v41
  v_xor_b32 v42, v7, v42
  v_xor_b32 v43, v7, v43
  v_xor_b32 v128, v7, v128
  v_xor_b32 v129, v7, v129
  v_xor_b32 v130, v7, v130
  v_xor_b32 v131, v7, v131
  v_xor_b32 v132, v7, v132
  v_xor_b32 v133, v7, v133
  v_xor_b32 v134, v7, v134
  v_xor_b32 v135, v7, v135
  v_xor_b32 v136, v7, v136
  v_xor_b32 v137, v7, v137
  v_xor_b32 v138, v7, v138
  v_xor_b32 v139, v7, v139
  v_xor_b32 v140, v7, v140
  v_xor_b32 v141, v7, v141
  v_xor_b32 v142, v7, v142
  v_xor_b32 v143, v7, v143
  v_or_b32 v8, v36, v37
  v_or3_b32 v8, v8, v38, v39
  v_or3_b32 v8, v8, v40, v41
  v_or3_b32 v8, v8, v42, v43
  v_or3_b32 v8, v8, v128, v129
  v_or3_b32 v8, v8, v130, v131
  v_or3_b32 v8, v8, v132, v133
  v_or3_b32 v8, v8, v134, v135
  v_or3_b32 v8, v8, v136, v137
  v_or3_b32 v8, v8, v138, v139
  v_or3_b32 v8, v8, v140, v141
  v_or3_b32 v8, v8, v142, v143
  v_and_b32 v8, s9, v8
  v_cmp_ne_u32 vcc, 0, v8
  s_and_b64 exec, exec, vcc
  s_cbranch_execz L_mok_27
  s_bcnt1_i32_b64 s7, exec
  s_cmp_lt_u32 s7, 60
  s_cbranch_scc1 L_nsl_28
  s_sleep 4
L_nsl_28:
  s_add_u32 s96, s96, 1
  s_cmp_lt_u32 s96, 400000
  s_cbranch_scc1 L_mp_26
  s_branch L_abort
L_mok_27:
  s_mov_b64 exec, -1
  v_perm_b32 v44, v37, v36, s61
  v_perm_b32 v45, v39, v38, s61
  v_perm_b32 v46, v41, v40, s61
  v_perm_b32 v47, v43, v42, s61
  v_dot2_f32_bf16 v48, v64, v44, 0
  v_add_f32 v8, v128, v129
  v_dot2_f32_bf16 v49, v68, v44, 0
  v_mul_f32 v10, v128, v128
  v_dot2_f32_bf16 v50, v65, v44, 0
  v_add_f32 v9, v130, v131
  v_dot2_f32_bf16 v51, v69, v44, 0
  v_mul_f32 v11, v129, v129
  v_dot2_f32_bf16 v52, v66, v44, 0
  v_fmac_f32 v10, v130, v130
  v_dot2_f32_bf16 v53, v70, v44, 0
  v_fmac_f32 v11, v131, v131
  v_dot2_f32_bf16 v54, v67, v44, 0
  v_add_f32 v8, v8, v132
  v_dot2_f32_bf16 v55, v71, v44, 0
  v_add_f32 v9, v9, v133
  v_dot2c_f32_bf16 v48, v72, v45
  v_fmac_f32 v10, v132, v132
  v_dot2c_f32_bf16 v49, v76, v45
  v_fmac_f32 v11, v133, v133
  v_dot2c_f32_bf16 v50, v73, v45
  v_add_f32 v8, v8, v134
  v_dot2c_f32_bf16 v51, v77, v45
  v_add_f32 v9, v9, v135
  v_dot2c_f32_bf16 v52, v74, v45
  v_fmac_f32 v10, v134, v134
  v_dot2c_f32_bf16 v53, v78, v45
  v_fmac_f32 v11, v135, v135
  v_dot2c_f32_bf16 v54, v75, v45
  v_add_f32 v8, v8, v136
  v_dot2c_f32_bf16 v55, v79, v45
  v_add_f32 v9, v9, v137
  v_dot2c_f32_bf16 v48, v80, v46
  v_fmac_f32 v10, v136, v136
  v_dot2c_f32_bf16 v49, v84, v46
  v_fmac_f32 v11, v137, v137
  v_dot2c_f32_bf16 v50, v81, v46
  v_add_f32 v8, v8, v138
  v_dot2c_f32_bf16 v51, v85, v46
  v_add_f32 v9, v9, v139
  v_dot2c_f32_bf16 v52, v82, v46
  v_fmac_f32 v10, v138, v138
  v_dot2c_f32_bf16 v53, v86, v46
  v_fmac_f32 v11, v139, v139
  v_dot2c_f32_bf16 v54, v83, v46
  v_add_f32 v8, v8, v140
  v_dot2c_f32_bf16 v55, v87, v46
  v_add_f32 v9, v9, v141
  v_dot2c_f32_bf16 v48, v88, v47
  v_fmac_f32 v10, v140, v140
  v_dot2c_f32_bf16 v49, v92, v47
  v_fmac_f32 v11, v141, v141
  v_dot2c_f32_bf16 v50, v89, v47
  v_add_f32 v8, v8, v142
  v_dot2c_f32_bf16 v51, v93, v47
  v_add_f32 v9, v9, v143
  v_dot2c_f32_bf16 v52, v90, v47
  v_fmac_f32 v10, v142, v142
  v_dot2c_f32_bf16 v53, v94, v47
  v_fmac_f32 v11, v143, v143
  v_dot2c_f32_bf16 v54, v91, v47
  v_add_f32 v8, v8, v9
  v_dot2c_f32_bf16 v55, v95, v47
  v_add_f32 v10, v10, v11
  v_dot2_f32_bf16 v56, v96, v44, 0
  v_add_f32_dpp v8, v8, v8 quad_perm:[1,0,3,2] row_mask:0xf bank_mask:0xf
  v_dot2_f32_bf16 v57, v100, v44, 0
  v_add_f32_dpp v10, v10, v10 quad_perm:[1,0,3,2] row_mask:0xf bank_mask:0xf
  v_dot2_f32_bf16 v58, v97, v44, 0
  v_add_f32_dpp v8, v8, v8 quad_perm:[2,3,0,1] row_mask:0xf bank_mask:0xf
  v_dot2_f32_bf16 v59, v101, v44, 0
  v_add_f32_dpp v10, v10, v10 quad_perm:[2,3,0,1] row_mask:0xf bank_mask:0xf
  v_dot2_f32_bf16 v60, v98, v44, 0
  v_add_f32_dpp v8, v8, v8 row_half_mirror row_mask:0xf bank_mask:0xf
  v_dot2_f32_bf16 v61, v102, v44, 0
  v_add_f32_dpp v10, v10, v10 row_half_mirror row_mask:0xf bank_mask:0xf
  v_dot2_f32_bf16 v62, v99, v44, 0
  v_add_f32_dpp v8, v8, v8 row_mirror row_mask:0xf bank_mask:0xf
  v_dot2_f32_bf16 v63, v103, v44, 0
  v_add_f32_dpp v10, v10, v10 row_mirror row_mask:0xf bank_mask:0xf
  v_dot2c_f32_bf16 v56, v104, v45
  v_mov_b32 v9, v8
  v_dot2c_f32_bf16 v57, v108, v45
  v_mov_b32 v11, v10
  v_dot2c_f32_bf16 v58, v105, v45
  v_permlane16_swap_b32 v9, v8
  v_dot2c_f32_bf16 v59, v109, v45
  v_permlane16_swap_b32 v11, v10
  v_dot2c_f32_bf16 v60, v106, v45
  v_add_f32 v8, v8, v9
  v_dot2c_f32_bf16 v61, v110, v45
  v_add_f32 v10, v10, v11
  v_dot2c_f32_bf16 v62, v107, v45
  v_mov_b32 v9, v8
  v_dot2c_f32_bf16 v63, v111, v45
  v_mov_b32 v11, v10
  v_dot2c_f32_bf16 v56, v112, v46
  v_permlane32_swap_b32 v9, v8
  v_dot2c_f32_bf16 v57, v116, v46
  v_permlane32_swap_b32 v11, v10
  v_dot2c_f32_bf16 v58, v113, v46
  v_add_f32 v8, v8, v9
  v_dot2c_f32_bf16 v59, v117, v46
  v_add_f32 v10, v10, v11
  v_dot2c_f32_bf16 v60, v114, v46
  v_mul_f32 v8, 0x3a800000, v8
  v_dot2c_f32_bf16 v61, v118, v46
  v_mul_f32 v9, 0x3a800000, v10
  v_dot2c_f32_bf16 v62, v115, v46
  v_fma_f32 v9, -v8, v8, v9
  v_dot2c_f32_bf16 v63, v119, v46
  v_max_f32 v9, 0, v9
  v_dot2c_f32_bf16 v56, v120, v47
  v_cvt_pk_bf16_f32 v10, v8, v8
  v_dot2c_f32_bf16 v57, v124, v47
  v_and_b32 v10, s97, v10
  v_dot2c_f32_bf16 v58, v121, v47
  v_cvt_pk_bf16_f32 v9, v9, v9
  v_dot2c_f32_bf16 v59, v125, v47
  v_and_b32 v9, s97, v9
  v_dot2c_f32_bf16 v60, v122, v47
  v_add_f32 v9, 0x3727c5ac, v9
  v_dot2c_f32_bf16 v61, v126, v47
  v_cvt_pk_bf16_f32 v9, v9, v9
  v_dot2c_f32_bf16 v62, v123, v47
  v_and_b32 v9, s97, v9
  v_dot2c_f32_bf16 v63, v127, v47
  v_sqrt_f32 v9, v9
  s_nop 0
  v_cvt_pk_bf16_f32 v11, v9, v9
  v_and_b32 v11, s97, v11
  v_rcp_f32 v12, v11
  v_permlane32_swap_b32 v48, v56
  v_permlane32_swap_b32 v49, v57
  v_permlane32_swap_b32 v50, v58
  v_permlane32_swap_b32 v51, v59
  v_permlane32_swap_b32 v52, v60
  v_permlane32_swap_b32 v53, v61
  v_permlane32_swap_b32 v54, v62
  v_permlane32_swap_b32 v55, v63
  v_add_f32 v48, v48, v56
  v_add_f32 v49, v49, v57
  v_add_f32 v50, v50, v58
  v_add_f32 v51, v51, v59
  v_add_f32 v52, v52, v60
  v_add_f32 v53, v53, v61
  v_add_f32 v54, v54, v62
  v_add_f32 v55, v55, v63
  v_permlane16_swap_b32 v48, v52
  v_permlane16_swap_b32 v49, v53
  v_permlane16_swap_b32 v50, v54
  v_permlane16_swap_b32 v51, v55
  v_add_f32 v48, v48, v52
  v_add_f32 v49, v49, v53
  v_add_f32 v50, v50, v54
  v_add_f32 v51, v51, v55
  v_add_f32_dpp v48, v48, v48 row_ror:8 row_mask:0xf bank_mask:0xf
  v_add_f32_dpp v49, v49, v49 row_ror:8 row_mask:0xf bank_mask:0xf
  v_add_f32_dpp v50, v50, v50 row_ror:8 row_mask:0xf bank_mask:0xf
  v_add_f32_dpp v51, v51, v51 row_ror:8 row_mask:0xf bank_mask:0xf
  s_mov_b64 exec, s[12:13]
  ds_write_b128 v5, v[48:51]
  s_mov_b64 exec, 1
  v_mov_b32 v11, v12
  v_mov_b32 v3, 122944
  ds_write_b64 v3, v[10:11]
  s_mov_b64 exec, -1
  s_waitcnt lgkmcnt(0)
  s_barrier
  s_endpgm
L_thi:
  v_lshlrev_b32 v8, 3, v0
  v_mov_b32 v10, 0
  v_mov_b32 v11, 0
  v_lshlrev_b32 v8, 5, v0
  ds_write_b32 v8, v10 offset:28
  ds_write_b32 v8, v10 offset:2076
  s_waitcnt lgkmcnt(0)
  s_load_dword s40, s[38:39], 0
  s_barrier
  s_barrier
  s_sub_u32 s44, s2, 224
  s_lshl_b32 s4, s44, 18
  s_add_u32 s56, s24, s4
  s_addc_u32 s57, s25, 0
  s_and_b32 s57, s57, 0xffff
  s_mov_b32 s58, 0x40000
  s_mov_b32 s59, 0x20000
  v_lshrrev_b32 v8, 4, v0
  v_lshlrev_b32 v8, 16, v8
  v_and_b32 v9, 15, v0
  v_lshl_add_u32 v8, v9, 4, v8
  s_lshl_b32 s5, s3, 8
  v_add_u32 v8, s5, v8
  s_mov_b32 s4, 0
  buffer_load_dwordx4 v[128:131], v8, s[56:59], s4 offen offset:0 nt
  buffer_load_dwordx4 v[132:135], v8, s[56:59], s4 offen offset:2048 nt
  s_mov_b32 s4, 4096
  buffer_load_dwordx4 v[136:139], v8, s[56:59], s4 offen offset:0 nt
  buffer_load_dwordx4 v[140:143], v8, s[56:59], s4 offen offset:2048 nt
  s_mov_b32 s4, 8192
  buffer_load_dwordx4 v[144:147], v8, s[56:59], s4 offen offset:0 nt
  buffer_load_dwordx4 v[148:151], v8, s[56:59], s4 offen offset:2048 nt
  s_mov_b32 s4, 12288
  buffer_load_dwordx4 v[152:155], v8, s[56:59], s4 offen offset:0 nt
  buffer_load_dwordx4 v[156:159], v8, s[56:59], s4 offen offset:2048 nt
  s_mov_b32 s4, 16384
  buffer_load_dwordx4 v[160:163], v8, s[56:59], s4 offen offset:0 nt
  buffer_load_dwordx4 v[164:167], v8, s[56:59], s4 offen offset:2048 nt
  s_mov_b32 s4, 20480
  buffer_load_dwordx4 v[168:171], v8, s[56:59], s4 offen offset:0 nt
  buffer_load_dwordx4 v[172:175], v8, s[56:59], s4 offen offset:2048 nt
  s_mov_b32 s4, 24576
  buffer_load_dwordx4 v[176:179], v8, s[56:59], s4 offen offset:0 nt
  buffer_load_dwordx4 v[180:183], v8, s[56:59], s4 offen offset:2048 nt
  s_mov_b32 s4, 28672
  buffer_load_dwordx4 v[184:187], v8, s[56:59], s4 offen offset:0 nt
  buffer_load_dwordx4 v[188:191], v8, s[56:59], s4 offen offset:2048 nt
  s_mov_b32 s4, 32768
  buffer_load_dwordx4 v[192:195], v8, s[56:59], s4 offen offset:0 nt
  buffer_load_dwordx4 v[196:199], v8, s[56:59], s4 offen offset:2048 nt
  s_mov_b32 s4, 36864
  buffer_load_dwordx4 v[200:203], v8, s[56:59], s4 offen offset:0 nt
  buffer_load_dwordx4 v[204:207], v8, s[56:59], s4 offen offset:2048 nt
  s_mov_b32 s4, 40960
  buffer_load_dwordx4 v[208:211], v8, s[56:59], s4 offen offset:0 nt
  buffer_load_dwordx4 v[212:215], v8, s[56:59], s4 offen offset:2048 nt
  s_mov_b32 s4, 45056
  buffer_load_dwordx4 v[216:219], v8, s[56:59], s4 offen offset:0 nt
  buffer_load_dwordx4 v[220:223], v8, s[56:59], s4 offen offset:2048 nt
  s_mov_b32 s4, 49152
  buffer_load_dwordx4 v[224:227], v8, s[56:59], s4 offen offset:0 nt
  buffer_load_dwordx4 v[228:231], v8, s[56:59], s4 offen offset:2048 nt
  s_mov_b32 s4, 53248
  buffer_load_dwordx4 v[232:235], v8, s[56:59], s4 offen offset:0 nt
  buffer_load_dwordx4 v[236:239], v8, s[56:59], s4 offen offset:2048 nt
  s_mov_b32 s4, 57344
  buffer_load_dwordx4 v[240:243], v8, s[56:59], s4 offen offset:0 nt
  buffer_load_dwordx4 v[244:247], v8, s[56:59], s4 offen offset:2048 nt
  s_mov_b32 s4, 61440
  buffer_load_dwordx4 v[248:251], v8, s[56:59], s4 offen offset:0 nt
  buffer_load_dwordx4 v[252:255], v8, s[56:59], s4 offen offset:2048 nt
  s_waitcnt lgkmcnt(0)
  s_add_u32 s40, s40, 1
  s_and_b32 s45, s40, 0xff
  s_and_b32 s46, s40, 0xfff
  s_and_b32 s47, s40, 0xffff
  s_branch L_tall
L_tlo:
  s_barrier
  s_waitcnt lgkmcnt(0)
  s_add_u32 s40, s40, 1
  s_and_b32 s45, s40, 0xff
  s_and_b32 s46, s40, 0xfff
  s_and_b32 s47, s40, 0xffff
  s_waitcnt vmcnt(8)
  v_lshlrev_b32 v32, 16, v16
  v_and_b32 v33, s97, v16
  v_lshlrev_b32 v34, 16, v17
  v_and_b32 v35, s97, v17
  v_lshlrev_b32 v36, 16, v18
  v_and_b32 v37, s97, v18
  v_lshlrev_b32 v38, 16, v19
  v_and_b32 v39, s97, v19
  v_lshlrev_b32 v40, 16, v20
  v_and_b32 v41, s97, v20
  v_lshlrev_b32 v42, 16, v21
  v_and_b32 v43, s97, v21
  v_lshlrev_b32 v44, 16, v22
  v_and_b32 v45, s97, v22
  v_lshlrev_b32 v46, 16, v23
  v_and_b32 v47, s97, v23
  v_add_f32 v48, v32, v33
  v_add_f32 v50, v34, v35
  v_add_f32 v48, v48, v36
  v_add_f32 v50, v50, v37
  v_add_f32 v48, v48, v38
  v_add_f32 v50, v50, v39
  v_add_f32 v48, v48, v40
  v_add_f32 v50, v50, v41
  v_add_f32 v48, v48, v42
  v_add_f32 v50, v50, v43
  v_add_f32 v48, v48, v44
  v_add_f32 v50, v50, v45
  v_add_f32 v48, v48, v46
  v_add_f32 v50, v50, v47
  v_add_f32 v48, v48, v50
  s_nop 1
  v_add_f32_dpp v48, v48, v48 quad_perm:[1,0,3,2] row_mask:0xf bank_mask:0xf
  s_nop 1
  v_add_f32_dpp v48, v48, v48 quad_perm:[2,3,0,1] row_mask:0xf bank_mask:0xf
  s_nop 1
  v_add_f32_dpp v48, v48, v48 row_half_mirror row_mask:0xf bank_mask:0xf
  s_nop 1
  v_add_f32_dpp v48, v48, v48 row_mirror row_mask:0xf bank_mask:0xf
  v_mov_b32 v49, v48
  s_nop 1
  v_permlane16_swap_b32 v49, v48
  v_add_f32 v48, v48, v49
  v_mov_b32 v49, v48
  s_nop 1
  v_permlane32_swap_b32 v49, v48
  v_add_f32 v48, v48, v49
  v_mul_f32 v48, 0x3a800000, v48
  v_sub_f32 v49, v32, v48
  v_mul_f32 v50, v49, v49
  v_sub_f32 v49, v33, v48
  v_fmac_f32 v50, v49, v49
  v_sub_f32 v49, v34, v48
  v_fmac_f32 v50, v49, v49
  v_sub_f32 v49, v35, v48
  v_fmac_f32 v50, v49, v49
  v_sub_f32 v49, v36, v48
  v_fmac_f32 v50, v49, v49
  v_sub_f32 v49, v37, v48
  v_fmac_f32 v50, v49, v49
  v_sub_f32 v49, v38, v48
  v_fmac_f32 v50, v49, v49
  v_sub_f32 v49, v39, v48
  v_fmac_f32 v50, v49, v49
  v_sub_f32 v49, v40, v48
  v_fmac_f32 v50, v49, v49
  v_sub_f32 v49, v41, v48
  v_fmac_f32 v50, v49, v49
  v_sub_f32 v49, v42, v48
  v_fmac_f32 v50, v49, v49
  v_sub_f32 v49, v43, v48
  v_fmac_f32 v50, v49, v49
  v_sub_f32 v49, v44, v48
  v_fmac_f32 v50, v49, v49
  v_sub_f32 v49, v45, v48
  v_fmac_f32 v50, v49, v49
  v_sub_f32 v49, v46, v48
  v_fmac_f32 v50, v49, v49
  v_sub_f32 v49, v47, v48
  v_fmac_f32 v50, v49, v49
  s_nop 1
  v_add_f32_dpp v50, v50, v50 quad_perm:[1,0,3,2] row_mask:0xf bank_mask:0xf
  s_nop 1
  v_add_f32_dpp v50, v50, v50 quad_perm:[2,3,0,1] row_mask:0xf bank_mask:0xf
  s_nop 1
  v_add_f32_dpp v50, v50, v50 row_half_mirror row_mask:0xf bank_mask:0xf
  s_nop 1
  v_add_f32_dpp v50, v50, v50 row_mirror row_mask:0xf bank_mask:0xf
  v_mov_b32 v49, v50
  s_nop 1
  v_permlane16_swap_b32 v49, v50
  v_add_f32 v50, v50, v49
  v_mov_b32 v49, v50
  s_nop 1
  v_permlane32_swap_b32 v49, v50
  v_add_f32 v50, v50, v49
  v_mul_f32 v50, 0x3a800000, v50
  v_cvt_pk_bf16_f32 v52, v48, v48
  v_and_b32 v52, s97, v52
  v_cvt_pk_bf16_f32 v50, v50, v50
  v_and_b32 v50, s97, v50
  v_add_f32 v50, 0x3727c5ac, v50
  v_cvt_pk_bf16_f32 v50, v50, v50
  v_and_b32 v50, s97, v50
  v_sqrt_f32 v50, v50
  s_nop 0
  v_cvt_pk_bf16_f32 v53, v50, v50
  v_and_b32 v53, s97, v53
  v_rcp_f32 v54, v53
  v_lshlrev_b32 v32, 16, v24
  v_and_b32 v33, s97, v24
  v_lshlrev_b32 v34, 16, v25
  v_and_b32 v35, s97, v25
  v_lshlrev_b32 v36, 16, v26
  v_and_b32 v37, s97, v26
  v_lshlrev_b32 v38, 16, v27
  v_and_b32 v39, s97, v27
  v_sub_f32 v56, v32, v52
  v_sub_f32 v57, v33, v52
  v_cvt_pk_bf16_f32 v57, v56, v57
  v_lshlrev_b32 v56, 16, v57
  v_and_b32 v57, s97, v57
  v_mul_f32 v58, v56, v54
  v_mul_f32 v59, v57, v54
  v_fma_f32 v56, -v58, v53, v56
  v_fma_f32 v57, -v59, v53, v57
  v_fmac_f32 v58, v56, v54
  v_fmac_f32 v59, v57, v54
  v_cvt_pk_bf16_f32 v16, v58, v59
  v_sub_f32 v56, v34, v52
  v_sub_f32 v57, v35, v52
  v_cvt_pk_bf16_f32 v57, v56, v57
  v_lshlrev_b32 v56, 16, v57
  v_and_b32 v57, s97, v57
  v_mul_f32 v58, v56, v54
  v_mul_f32 v59, v57, v54
  v_fma_f32 v56, -v58, v53, v56
  v_fma_f32 v57, -v59, v53, v57
  v_fmac_f32 v58, v56, v54
  v_fmac_f32 v59, v57, v54
  v_cvt_pk_bf16_f32 v17, v58, v59
  v_sub_f32 v56, v36, v52
  v_sub_f32 v57, v37, v52
  v_cvt_pk_bf16_f32 v57, v56, v57
  v_lshlrev_b32 v56, 16, v57
  v_and_b32 v57, s97, v57
  v_mul_f32 v58, v56, v54
  v_mul_f32 v59, v57, v54
  v_fma_f32 v56, -v58, v53, v56
  v_fma_f32 v57, -v59, v53, v57
  v_fmac_f32 v58, v56, v54
  v_fmac_f32 v59, v57, v54
  v_cvt_pk_bf16_f32 v18, v58, v59
  v_sub_f32 v56, v38, v52
  v_sub_f32 v57, v39, v52
  v_cvt_pk_bf16_f32 v57, v56, v57
  v_lshlrev_b32 v56, 16, v57
  v_and_b32 v57, s97, v57
  v_mul_f32 v58, v56, v54
  v_mul_f32 v59, v57, v54
  v_fma_f32 v56, -v58, v53, v56
  v_fma_f32 v57, -v59, v53, v57
  v_fmac_f32 v58, v56, v54
  v_fmac_f32 v59, v57, v54
  v_cvt_pk_bf16_f32 v19, v58, v59
  s_waitcnt vmcnt(0)
  v_perm_b32 v20, v68, v64, s60
  v_perm_b32 v21, v68, v64, s61
  v_dot2_f32_bf16 v32, v20, v16, 0
  v_dot2_f32_bf16 v33, v21, v16, 0
  v_perm_b32 v22, v69, v65, s60
  v_perm_b32 v23, v69, v65, s61
  v_dot2_f32_bf16 v34, v22, v16, 0
  v_dot2_f32_bf16 v35, v23, v16, 0
  v_perm_b32 v20, v70, v66, s60
  v_perm_b32 v21, v70, v66, s61
  v_dot2_f32_bf16 v36, v20, v16, 0
  v_dot2_f32_bf16 v37, v21, v16, 0
  v_perm_b32 v22, v71, v67, s60
  v_perm_b32 v23, v71, v67, s61
  v_dot2_f32_bf16 v38, v22, v16, 0
  v_dot2_f32_bf16 v39, v23, v16, 0
  v_perm_b32 v20, v76, v72, s60
  v_perm_b32 v21, v76, v72, s61
  v_dot2_f32_bf16 v32, v20, v17, v32
  v_dot2_f32_bf16 v33, v21, v17, v33
  v_perm_b32 v22, v77, v73, s60
  v_perm_b32 v23, v77, v73, s61
  v_dot2_f32_bf16 v34, v22, v17, v34
  v_dot2_f32_bf16 v35, v23, v17, v35
  v_perm_b32 v20, v78, v74, s60
  v_perm_b32 v21, v78, v74, s61
  v_dot2_f32_bf16 v36, v20, v17, v36
  v_dot2_f32_bf16 v37, v21, v17, v37
  v_perm_b32 v22, v79, v75, s60
  v_perm_b32 v23, v79, v75, s61
  v_dot2_f32_bf16 v38, v22, v17, v38
  v_dot2_f32_bf16 v39, v23, v17, v39
  v_perm_b32 v20, v84, v80, s60
  v_perm_b32 v21, v84, v80, s61
  v_dot2_f32_bf16 v32, v20, v18, v32
  v_dot2_f32_bf16 v33, v21, v18, v33
  v_perm_b32 v22, v85, v81, s60
  v_perm_b32 v23, v85, v81, s61
  v_dot2_f32_bf16 v34, v22, v18, v34
  v_dot2_f32_bf16 v35, v23, v18, v35
  v_perm_b32 v20, v86, v82, s60
  v_perm_b32 v21, v86, v82, s61
  v_dot2_f32_bf16 v36, v20, v18, v36
  v_dot2_f32_bf16 v37, v21, v18, v37
  v_perm_b32 v22, v87, v83, s60
  v_perm_b32 v23, v87, v83, s61
  v_dot2_f32_bf16 v38, v22, v18, v38
  v_dot2_f32_bf16 v39, v23, v18, v39
  v_perm_b32 v20, v92, v88, s60
  v_perm_b32 v21, v92, v88, s61
  v_dot2_f32_bf16 v32, v20, v19, v32
  v_dot2_f32_bf16 v33, v21, v19, v33
  v_perm_b32 v22, v93, v89, s60
  v_perm_b32 v23, v93, v89, s61
  v_dot2_f32_bf16 v34, v22, v19, v34
  v_dot2_f32_bf16 v35, v23, v19, v35
  v_perm_b32 v20, v94, v90, s60
  v_perm_b32 v21, v94, v90, s61
  v_dot2_f32_bf16 v36, v20, v19, v36
  v_dot2_f32_bf16 v37, v21, v19, v37
  v_perm_b32 v22, v95, v91, s60
  v_perm_b32 v23, v95, v91, s61
  v_dot2_f32_bf16 v38, v22, v19, v38
  v_dot2_f32_bf16 v39, v23, v19, v39
  v_permlane32_swap_b32 v32, v36
  v_permlane32_swap_b32 v33, v37
  v_permlane32_swap_b32 v34, v38
  v_permlane32_swap_b32 v35, v39
  v_add_f32 v32, v32, v36
  v_add_f32 v33, v33, v37
  v_add_f32 v34, v34, v38
  v_add_f32 v35, v35, v39
  s_nop 0
  v_permlane16_swap_b32 v32, v34
  v_permlane16_swap_b32 v33, v35
  v_add_f32 v32, v32, v34
  v_add_f32 v33, v33, v35
  s_nop 0
  v_add_f32_dpp v32, v32, v32 row_ror:8 row_mask:0xf bank_mask:0xf
  v_add_f32_dpp v33, v33, v33 row_ror:8 row_mask:0xf bank_mask:0xf
  v_and_b32 v20, 7, v0
  v_lshlrev_b32 v20, 5, v20
  v_lshrrev_b32 v21, 5, v0
  v_lshl_add_u32 v20, v21, 4, v20
  v_bfe_u32 v21, v0, 4, 1
  v_lshl_add_u32 v20, v21, 3, v20
  s_lshl_b32 s4, s3, 8
  s_add_u32 s4, s4, 100352
  v_add_u32 v20, s4, v20
  ds_write_b64 v20, v[32:33]
  s_waitcnt lgkmcnt(0)
  s_mov_b64 exec, 1
  v_mov_b32 v7, 1
  ds_add_rtn_u32 v8, v6, v7
  s_waitcnt lgkmcnt(0)
  v_readfirstlane_b32 s4, v8
  s_mov_b64 exec, -1
  s_cmp_eq_u32 s4, 3
  s_cbranch_scc0 L_qnl_29
  s_mov_b64 exec, 0xffff
  v_add_u32 v20, 100352, v2
  ds_read_b128 v[32:35], v20 offset:0
  ds_read_b128 v[36:39], v20 offset:256
  ds_read_b128 v[40:43], v20 offset:512
  ds_read_b128 v[44:47], v20 offset:768
  s_lshr_b32 s4, s14, 4
  s_lshl_b32 s4, s4, 14
  s_lshl_b32 s5, s15, 12
  s_add_u32 s4, s4, s5
  s_and_b32 s5, s14, 15
  s_lshl_b32 s5, s5, 8
  s_add_u32 s4, s4, s5
  s_add_u32 s4, s4, 4096
  v_add_u32 v21, s4, v2
  v_mov_b32 v22, s45
  s_and_b32 s5, s2, 63
  s_cmp_eq_u32 s5, 0
  s_cbranch_scc0 L_noc_30
  s_lshl_b32 s5, s2, 5
  s_add_u32 s5, s5, 98304
  v_lshlrev_b32 v23, 8, v0
  v_and_b32 v23, 0x7ff, v23
  v_add_u32 v23, s5, v23
  v_mov_b32 v24, 0
  global_store_dword v23, v24, s[38:39] sc1
  s_waitcnt vmcnt(0)
L_noc_30:
  s_waitcnt lgkmcnt(0)
  v_add_f32 v32, v32, v36
  v_add_f32 v40, v40, v44
  v_add_f32 v33, v33, v37
  v_add_f32 v41, v41, v45
  v_add_f32 v34, v34, v38
  v_add_f32 v42, v42, v46
  v_add_f32 v35, v35, v39
  v_add_f32 v43, v43, v47
  v_add_f32 v32, v32, v40
  v_add_f32 v33, v33, v41
  v_add_f32 v34, v34, v42
  v_add_f32 v35, v35, v43
  v_and_or_b32 v32, v32, s98, v22
  v_and_or_b32 v33, v33, s98, v22
  v_and_or_b32 v34, v34, s98, v22
  v_and_or_b32 v35, v35, s98, v22
  global_store_dwordx4 v21, v[32:35], s[38:39] sc1
  s_mov_b64 exec, -1
L_qnl_29:
  s_barrier
  s_sub_u32 s44, s2, 224
  s_lshl_b32 s4, s44, 18
  s_add_u32 s56, s24, s4
  s_addc_u32 s57, s25, 0
  s_and_b32 s57, s57, 0xffff
  s_mov_b32 s58, 0x40000
  s_mov_b32 s59, 0x20000
  v_lshrrev_b32 v8, 4, v0
  v_lshlrev_b32 v8, 16, v8
  v_and_b32 v9, 15, v0
  v_lshl_add_u32 v8, v9, 4, v8
  s_lshl_b32 s5, s3, 8
  v_add_u32 v8, s5, v8
  s_mov_b32 s4, 0
  buffer_load_dwordx4 v[128:131], v8, s[56:59], s4 offen offset:0 nt
  buffer_load_dwordx4 v[132:135], v8, s[56:59], s4 offen offset:2048 nt
  s_mov_b32 s4, 4096
  buffer_load_dwordx4 v[136:139], v8, s[56:59], s4 offen offset:0 nt
  buffer_load_dwordx4 v[140:143], v8, s[56:59], s4 offen offset:2048 nt
  s_mov_b32 s4, 8192
  buffer_load_dwordx4 v[144:147], v8, s[56:59], s4 offen offset:0 nt
  buffer_load_dwordx4 v[148:151], v8, s[56:59], s4 offen offset:2048 nt
  s_mov_b32 s4, 12288
  buffer_load_dwordx4 v[152:155], v8, s[56:59], s4 offen offset:0 nt
  buffer_load_dwordx4 v[156:159], v8, s[56:59], s4 offen offset:2048 nt
  s_mov_b32 s4, 16384
  buffer_load_dwordx4 v[160:163], v8, s[56:59], s4 offen offset:0 nt
  buffer_load_dwordx4 v[164:167], v8, s[56:59], s4 offen offset:2048 nt
  s_mov_b32 s4, 20480
  buffer_load_dwordx4 v[168:171], v8, s[56:59], s4 offen offset:0 nt
  buffer_load_dwordx4 v[172:175], v8, s[56:59], s4 offen offset:2048 nt
  s_mov_b32 s4, 24576
  buffer_load_dwordx4 v[176:179], v8, s[56:59], s4 offen offset:0 nt
  buffer_load_dwordx4 v[180:183], v8, s[56:59], s4 offen offset:2048 nt
  s_mov_b32 s4, 28672
  buffer_load_dwordx4 v[184:187], v8, s[56:59], s4 offen offset:0 nt
  buffer_load_dwordx4 v[188:191], v8, s[56:59], s4 offen offset:2048 nt
  s_mov_b32 s4, 32768
  buffer_load_dwordx4 v[192:195], v8, s[56:59], s4 offen offset:0 nt
  buffer_load_dwordx4 v[196:199], v8, s[56:59], s4 offen offset:2048 nt
  s_mov_b32 s4, 36864
  buffer_load_dwordx4 v[200:203], v8, s[56:59], s4 offen offset:0 nt
  buffer_load_dwordx4 v[204:207], v8, s[56:59], s4 offen offset:2048 nt
  s_mov_b32 s4, 40960
  buffer_load_dwordx4 v[208:211], v8, s[56:59], s4 offen offset:0 nt
  buffer_load_dwordx4 v[212:215], v8, s[56:59], s4 offen offset:2048 nt
  s_mov_b32 s4, 45056
  buffer_load_dwordx4 v[216:219], v8, s[56:59], s4 offen offset:0 nt
  buffer_load_dwordx4 v[220:223], v8, s[56:59], s4 offen offset:2048 nt
  s_mov_b32 s4, 49152
  buffer_load_dwordx4 v[224:227], v8, s[56:59], s4 offen offset:0 nt
  buffer_load_dwordx4 v[228:231], v8, s[56:59], s4 offen offset:2048 nt
  s_mov_b32 s4, 53248
  buffer_load_dwordx4 v[232:235], v8, s[56:59], s4 offen offset:0 nt
  buffer_load_dwordx4 v[236:239], v8, s[56:59], s4 offen offset:2048 nt
  s_mov_b32 s4, 57344
  buffer_load_dwordx4 v[240:243], v8, s[56:59], s4 offen offset:0 nt
  buffer_load_dwordx4 v[244:247], v8, s[56:59], s4 offen offset:2048 nt
  s_mov_b32 s4, 61440
  buffer_load_dwordx4 v[248:251], v8, s[56:59], s4 offen offset:0 nt
  buffer_load_dwordx4 v[252:255], v8, s[56:59], s4 offen offset:2048 nt
L_tall:
  s_waitcnt vmcnt(0)
  v_perm_b32 v52, v132, v128, s60
  v_perm_b32 v132, v132, v128, s61
  v_mov_b32 v128, v52
  v_perm_b32 v53, v133, v129, s60
  v_perm_b32 v133, v133, v129, s61
  v_mov_b32 v129, v53
  v_perm_b32 v52, v134, v130, s60
  v_perm_b32 v134, v134, v130, s61
  v_mov_b32 v130, v52
  v_perm_b32 v53, v135, v131, s60
  v_perm_b32 v135, v135, v131, s61
  v_mov_b32 v131, v53
  v_perm_b32 v52, v140, v136, s60
  v_perm_b32 v140, v140, v136, s61
  v_mov_b32 v136, v52
  v_perm_b32 v53, v141, v137, s60
  v_perm_b32 v141, v141, v137, s61
  v_mov_b32 v137, v53
  v_perm_b32 v52, v142, v138, s60
  v_perm_b32 v142, v142, v138, s61
  v_mov_b32 v138, v52
  v_perm_b32 v53, v143, v139, s60
  v_perm_b32 v143, v143, v139, s61
  v_mov_b32 v139, v53
  v_perm_b32 v52, v148, v144, s60
  v_perm_b32 v148, v148, v144, s61
  v_mov_b32 v144, v52
  v_perm_b32 v53, v149, v145, s60
  v_perm_b32 v149, v149, v145, s61
  v_mov_b32 v145, v53
  v_perm_b32 v52, v150, v146, s60
  v_perm_b32 v150, v150, v146, s61
  v_mov_b32 v146, v52
  v_perm_b32 v53, v151, v147, s60
  v_perm_b32 v151, v151, v147, s61
  v_mov_b32 v147, v53
  v_perm_b32 v52, v156, v152, s60
  v_perm_b32 v156, v156, v152, s61
  v_mov_b32 v152, v52
  v_perm_b32 v53, v157, v153, s60
  v_perm_b32 v157, v157, v153, s61
  v_mov_b32 v153, v53
  v_perm_b32 v52, v158, v154, s60
  v_perm_b32 v158, v158, v154, s61
  v_mov_b32 v154, v52
  v_perm_b32 v53, v159, v155, s60
  v_perm_b32 v159, v159, v155, s61
  v_mov_b32 v155, v53
  v_perm_b32 v52, v164, v160, s60
  v_perm_b32 v164, v164, v160, s61
  v_mov_b32 v160, v52
  v_perm_b32 v53, v165, v161, s60
  v_perm_b32 v165, v165, v161, s61
  v_mov_b32 v161, v53
  v_perm_b32 v52, v166, v162, s60
  v_perm_b32 v166, v166, v162, s61
  v_mov_b32 v162, v52
  v_perm_b32 v53, v167, v163, s60
  v_perm_b32 v167, v167, v163, s61
  v_mov_b32 v163, v53
  v_perm_b32 v52, v172, v168, s60
  v_perm_b32 v172, v172, v168, s61
  v_mov_b32 v168, v52
  v_perm_b32 v53, v173, v169, s60
  v_perm_b32 v173, v173, v169, s61
  v_mov_b32 v169, v53
  v_perm_b32 v52, v174, v170, s60
  v_perm_b32 v174, v174, v170, s61
  v_mov_b32 v170, v52
  v_perm_b32 v53, v175, v171, s60
  v_perm_b32 v175, v175, v171, s61
  v_mov_b32 v171, v53
  v_perm_b32 v52, v180, v176, s60
  v_perm_b32 v180, v180, v176, s61
  v_mov_b32 v176, v52
  v_perm_b32 v53, v181, v177, s60
  v_perm_b32 v181, v181, v177, s61
  v_mov_b32 v177, v53
  v_perm_b32 v52, v182, v178, s60
  v_perm_b32 v182, v182, v178, s61
  v_mov_b32 v178, v52
  v_perm_b32 v53, v183, v179, s60
  v_perm_b32 v183, v183, v179, s61
  v_mov_b32 v179, v53
  v_perm_b32 v52, v188, v184, s60
  v_perm_b32 v188, v188, v184, s61
  v_mov_b32 v184, v52
  v_perm_b32 v53, v189, v185, s60
  v_perm_b32 v189, v189, v185, s61
  v_mov_b32 v185, v53
  v_perm_b32 v52, v190, v186, s60
  v_perm_b32 v190, v190, v186, s61
  v_mov_b32 v186, v52
  v_perm_b32 v53, v191, v187, s60
  v_perm_b32 v191, v191, v187, s61
  v_mov_b32 v187, v53
  v_perm_b32 v52, v196, v192, s60
  v_perm_b32 v196, v196, v192, s61
  v_mov_b32 v192, v52
  v_perm_b32 v53, v197, v193, s60
  v_perm_b32 v197, v197, v193, s61
  v_mov_b32 v193, v53
  v_perm_b32 v52, v198, v194, s60
  v_perm_b32 v198, v198, v194, s61
  v_mov_b32 v194, v52
  v_perm_b32 v53, v199, v195, s60
  v_perm_b32 v199, v199, v195, s61
  v_mov_b32 v195, v53
  v_perm_b32 v52, v204, v200, s60
  v_perm_b32 v204, v204, v200, s61
  v_mov_b32 v200, v52
  v_perm_b32 v53, v205, v201, s60
  v_perm_b32 v205, v205, v201, s61
  v_mov_b32 v201, v53
  v_perm_b32 v52, v206, v202, s60
  v_perm_b32 v206, v206, v202, s61
  v_mov_b32 v202, v52
  v_perm_b32 v53, v207, v203, s60
  v_perm_b32 v207, v207, v203, s61
  v_mov_b32 v203, v53
  v_perm_b32 v52, v212, v208, s60
  v_perm_b32 v212, v212, v208, s61
  v_mov_b32 v208, v52
  v_perm_b32 v53, v213, v209, s60
  v_perm_b32 v213, v213, v209, s61
  v_mov_b32 v209, v53
  v_perm_b32 v52, v214, v210, s60
  v_perm_b32 v214, v214, v210, s61
  v_mov_b32 v210, v52
  v_perm_b32 v53, v215, v211, s60
  v_perm_b32 v215, v215, v211, s61
  v_mov_b32 v211, v53
  v_perm_b32 v52, v220, v216, s60
  v_perm_b32 v220, v220, v216, s61
  v_mov_b32 v216, v52
  v_perm_b32 v53, v221, v217, s60
  v_perm_b32 v221, v221, v217, s61
  v_mov_b32 v217, v53
  v_perm_b32 v52, v222, v218, s60
  v_perm_b32 v222, v222, v218, s61
  v_mov_b32 v218, v52
  v_perm_b32 v53, v223, v219, s60
  v_perm_b32 v223, v223, v219, s61
  v_mov_b32 v219, v53
  v_perm_b32 v52, v228, v224, s60
  v_perm_b32 v228, v228, v224, s61
  v_mov_b32 v224, v52
  v_perm_b32 v53, v229, v225, s60
  v_perm_b32 v229, v229, v225, s61
  v_mov_b32 v225, v53
  v_perm_b32 v52, v230, v226, s60
  v_perm_b32 v230, v230, v226, s61
  v_mov_b32 v226, v52
  v_perm_b32 v53, v231, v227, s60
  v_perm_b32 v231, v231, v227, s61
  v_mov_b32 v227, v53
  v_perm_b32 v52, v236, v232, s60
  v_perm_b32 v236, v236, v232, s61
  v_mov_b32 v232, v52
  v_perm_b32 v53, v237, v233, s60
  v_perm_b32 v237, v237, v233, s61
  v_mov_b32 v233, v53
  v_perm_b32 v52, v238, v234, s60
  v_perm_b32 v238, v238, v234, s61
  v_mov_b32 v234, v52
  v_perm_b32 v53, v239, v235, s60
  v_perm_b32 v239, v239, v235, s61
  v_mov_b32 v235, v53
  v_perm_b32 v52, v244, v240, s60
  v_perm_b32 v244, v244, v240, s61
  v_mov_b32 v240, v52
  v_perm_b32 v53, v245, v241, s60
  v_perm_b32 v245, v245, v241, s61
  v_mov_b32 v241, v53
  v_perm_b32 v52, v246, v242, s60
  v_perm_b32 v246, v246, v242, s61
  v_mov_b32 v242, v52
  v_perm_b32 v53, v247, v243, s60
  v_perm_b32 v247, v247, v243, s61
  v_mov_b32 v243, v53
  v_perm_b32 v52, v252, v248, s60
  v_perm_b32 v252, v252, v248, s61
  v_mov_b32 v248, v52
  v_perm_b32 v53, v253, v249, s60
  v_perm_b32 v253, v253, v249, s61
  v_mov_b32 v249, v53
  v_perm_b32 v52, v254, v250, s60
  v_perm_b32 v254, v254, v250, s61
  v_mov_b32 v250, v52
  v_perm_b32 v53, v255, v251, s60
  v_perm_b32 v255, v255, v251, s61
  v_mov_b32 v251, v53
  v_mov_b32 v28, s46
  s_mov_b32 s6, 0xfff
  s_mul_i32 s9, s44, 4224
  s_lshl_b32 s10, s3, 9
  s_add_u32 s9, s9, s10
  s_add_u32 s9, s9, 1376256
  v_and_b32 v48, 15, v0
  v_lshlrev_b32 v48, 5, v48
  v_lshrrev_b32 v49, 5, v0
  v_lshl_add_u32 v48, v49, 4, v48
  v_add_u32 v48, s9, v48
  v_mov_b32 v50, s46
  v_lshrrev_b32 v62, 4, v0
  v_lshlrev_b32 v62, 6, v62
  v_add_u32 v62, 4096, v62
  s_lshr_b32 s4, s44, 3
  s_lshl_b32 s4, s4, 6
  s_and_b32 s5, s44, 7
  s_cmp_eq_u32 s3, 7
  s_cbranch_scc1 L_w7_31
  s_lshl_b32 s7, s3, 3
  s_add_u32 s4, s4, s7
  v_lshrrev_b32 v24, 5, v0
  v_add_u32 v24, s4, v24
  s_mov_b32 s7, 4224
  v_mul_lo_u32 v25, v24, s7
  v_and_b32 v26, 31, v0
  v_lshl_add_u32 v25, v26, 4, v25
  s_lshl_b32 s5, s5, 9
  s_add_u32 s5, s5, 262144
  v_add_u32 v25, s5, v25
  v_add_u32 v13, 8448, v25
  v_add_u32 v14, 16896, v25
  v_add_u32 v15, 25344, v25
  v_lshrrev_b32 v27, 5, v0
  v_lshlrev_b32 v27, 4, v27
  s_lshl_b32 s4, s3, 5
  s_add_u32 s4, s4, 4608
  v_add_u32 v27, s4, v27
  v_bfe_u32 v57, v0, 3, 2
  v_lshlrev_b32 v57, 5, v57
  v_lshrrev_b32 v58, 5, v0
  v_lshl_add_u32 v57, v58, 4, v57
  v_and_b32 v58, 7, v0
  v_add_u32 v57, v57, v58
  v_lshlrev_b32 v59, 5, v57
  s_lshl_b32 s4, s3, 2
  v_add_u32 v59, s4, v59
  s_lshl_b32 s4, s3, 6
  v_add_u32 v60, s4, v0
  v_lshlrev_b32 v61, 1, v60
  v_add_u32 v61, 4096, v61
  v_lshlrev_b32 v60, 5, v60
  s_mov_b32 s96, 0
L_mp_33:
  global_load_dwordx4 v[80:83], v25, s[38:39] sc1
  global_load_dwordx4 v[84:87], v13, s[38:39] sc1
  global_load_dwordx4 v[88:91], v14, s[38:39] sc1
  global_load_dwordx4 v[92:95], v15, s[38:39] sc1
  s_waitcnt vmcnt(0)
  v_xor_b32 v80, v28, v80
  v_xor_b32 v81, v28, v81
  v_xor_b32 v82, v28, v82
  v_xor_b32 v83, v28, v83
  v_xor_b32 v84, v28, v84
  v_xor_b32 v85, v28, v85
  v_xor_b32 v86, v28, v86
  v_xor_b32 v87, v28, v87
  v_xor_b32 v88, v28, v88
  v_xor_b32 v89, v28, v89
  v_xor_b32 v90, v28, v90
  v_xor_b32 v91, v28, v91
  v_xor_b32 v92, v28, v92
  v_xor_b32 v93, v28, v93
  v_xor_b32 v94, v28, v94
  v_xor_b32 v95, v28, v95
  v_or_b32 v29, v80, v81
  v_or3_b32 v29, v29, v82, v83
  v_or3_b32 v29, v29, v84, v85
  v_or3_b32 v29, v29, v86, v87
  v_or3_b32 v29, v29, v88, v89
  v_or3_b32 v29, v29, v90, v91
  v_or3_b32 v29, v29, v92, v93
  v_or3_b32 v29, v29, v94, v95
  v_and_b32 v29, s6, v29
  v_cmp_ne_u32 vcc, 0, v29
  s_and_b64 exec, exec, vcc
  s_cbranch_execz L_mok_34
  s_bcnt1_i32_b64 s7, exec
  s_cmp_lt_u32 s7, 60
  s_cbranch_scc1 L_nsl_35
  s_sleep 16
L_nsl_35:
  s_add_u32 s96, s96, 1
  s_cmp_lt_u32 s96, 400000
  s_cbranch_scc1 L_mp_33
  s_branch L_abort
L_mok_34:
  s_mov_b64 exec, -1
  s_barrier
  ds_read_b128 v[64:67], v27
  s_waitcnt lgkmcnt(0)
  v_mul_f32 v44, v64, v80
  v_mul_f32 v45, v64, v81
  v_mul_f32 v46, v64, v82
  v_mul_f32 v47, v64, v83
  v_fmac_f32 v44, v65, v84
  v_fmac_f32 v45, v65, v85
  v_fmac_f32 v46, v65, v86
  v_fmac_f32 v47, v65, v87
  v_fmac_f32 v44, v66, v88
  v_fmac_f32 v45, v66, v89
  v_fmac_f32 v46, v66, v90
  v_fmac_f32 v47, v66, v91
  v_fmac_f32 v44, v67, v92
  v_fmac_f32 v45, v67, v93
  v_fmac_f32 v46, v67, v94
  v_fmac_f32 v47, v67, v95
  s_nop 0
  v_permlane32_swap_b32 v44, v46
  v_permlane32_swap_b32 v45, v47
  v_add_f32 v44, v44, v46
  v_add_f32 v45, v45, v47
  ds_write_b32 v59, v44
  ds_write_b32 v59, v45 offset:256
  s_branch L_w7d_32
L_w7_31:
  v_min_u32 v26, 55, v0
  v_add_u32 v26, s4, v26
  s_mov_b32 s7, 4224
  v_mul_lo_u32 v26, v26, s7
  s_lshl_b32 s5, s5, 4
  s_add_u32 s5, s5, 266240
  v_add_u32 v26, s5, v26
  v_and_b32 v27, 56, v0
  v_and_b32 v24, 1, v0
  v_lshl_add_u32 v27, v24, 2, v27
  v_bfe_u32 v24, v0, 1, 2
  v_add_u32 v27, v27, v24
  v_lshlrev_b32 v27, 2, v27
  v_add_u32 v27, 4608, v27
  s_mov_b32 s96, 0
L_mp_36:
  global_load_dwordx4 v[32:35], v26, s[38:39] sc1
  s_waitcnt vmcnt(0)
  v_xor_b32 v32, v28, v32
  v_xor_b32 v33, v28, v33
  v_xor_b32 v34, v28, v34
  v_xor_b32 v35, v28, v35
  v_or_b32 v29, v32, v33
  v_or3_b32 v29, v29, v34, v35
  v_and_b32 v29, s6, v29
  v_cmp_ne_u32 vcc, 0, v29
  s_and_b64 exec, exec, vcc
  s_cbranch_execz L_mok_37
  s_add_u32 s96, s96, 1
  s_cmp_lt_u32 s96, 400000
  s_cbranch_scc1 L_mp_36
  s_branch L_abort
L_mok_37:
  s_mov_b64 exec, -1
  v_mov_b32 v56, v32
  s_nop 1
  v_max_f32_dpp v56, v56, v56 quad_perm:[1,0,3,2] row_mask:0xf bank_mask:0xf
  s_nop 1
  v_max_f32_dpp v56, v56, v56 quad_perm:[2,3,0,1] row_mask:0xf bank_mask:0xf
  s_nop 1
  v_max_f32_dpp v56, v56, v56 row_half_mirror row_mask:0xf bank_mask:0xf
  s_nop 1
  v_max_f32_dpp v56, v56, v56 row_mirror row_mask:0xf bank_mask:0xf
  v_mov_b32 v57, v56
  s_nop 1
  v_permlane16_swap_b32 v57, v56
  v_max_f32 v56, v56, v57
  v_mov_b32 v57, v56
  s_nop 1
  v_permlane32_swap_b32 v57, v56
  v_max_f32 v56, v56, v57
  v_sub_f32 v32, v32, v56
  v_mul_f32 v32, s63, v32
  v_exp_f32 v32, v32
  v_cmp_gt_u32 vcc, 56, v0
  v_mul_f32 v33, v32, v33
  s_nop 0
  v_cndmask_b32 v33, 0, v33, vcc
  s_nop 1
  v_add_f32_dpp v33, v33, v33 quad_perm:[1,0,3,2] row_mask:0xf bank_mask:0xf
  s_nop 1
  v_add_f32_dpp v33, v33, v33 quad_perm:[2,3,0,1] row_mask:0xf bank_mask:0xf
  s_nop 1
  v_add_f32_dpp v33, v33, v33 row_half_mirror row_mask:0xf bank_mask:0xf
  s_nop 1
  v_add_f32_dpp v33, v33, v33 row_mirror row_mask:0xf bank_mask:0xf
  v_mov_b32 v57, v33
  s_nop 1
  v_permlane16_swap_b32 v57, v33
  v_add_f32 v33, v33, v57
  v_mov_b32 v57, v33
  s_nop 1
  v_permlane32_swap_b32 v57, v33
  v_add_f32 v33, v33, v57
  v_rcp_f32 v33, v33
  s_nop 0
  v_mul_f32 v32, v32, v33
  ds_write_b32 v27, v32
  s_waitcnt lgkmcnt(0)
  s_barrier
L_w7d_32:
  s_waitcnt lgkmcnt(0)
  s_barrier
  s_cmp_lt_u32 s3, 2
  s_cbranch_scc0 L_st1_38
  ds_read_b128 v[36:39], v60
  ds_read_b128 v[40:43], v60 offset:16
  s_waitcnt lgkmcnt(0)
  v_add_f32 v36, v36, v40
  v_add_f32 v37, v37, v41
  v_add_f32 v38, v38, v42
  v_add_f32 v39, v39, v43
  v_add_f32 v36, v36, v37
  v_add_f32 v38, v38, v39
  v_add_f32 v36, v36, v38
  v_cvt_pk_bf16_f32 v36, v36, v36
  ds_write_b16 v61, v36
  s_waitcnt lgkmcnt(0)
L_st1_38:
  s_barrier
  ds_read_b128 v[64:67], v62 offset:0
  ds_read_b128 v[68:71], v62 offset:16
  ds_read_b128 v[72:75], v62 offset:32
  ds_read_b128 v[76:79], v62 offset:48
  s_waitcnt lgkmcnt(0)
  v_dot2_f32_bf16 v32, v128, v64, 0
  v_dot2_f32_bf16 v33, v132, v64, 0
  v_dot2_f32_bf16 v34, v129, v64, 0
  v_dot2_f32_bf16 v35, v133, v64, 0
  v_dot2_f32_bf16 v36, v130, v64, 0
  v_dot2_f32_bf16 v37, v134, v64, 0
  v_dot2_f32_bf16 v38, v131, v64, 0
  v_dot2_f32_bf16 v39, v135, v64, 0
  v_dot2c_f32_bf16 v32, v136, v65
  v_dot2c_f32_bf16 v33, v140, v65
  v_dot2c_f32_bf16 v34, v137, v65
  v_dot2c_f32_bf16 v35, v141, v65
  v_dot2c_f32_bf16 v36, v138, v65
  v_dot2c_f32_bf16 v37, v142, v65
  v_dot2c_f32_bf16 v38, v139, v65
  v_dot2c_f32_bf16 v39, v143, v65
  v_dot2c_f32_bf16 v32, v144, v66
  v_dot2c_f32_bf16 v33, v148, v66
  v_dot2c_f32_bf16 v34, v145, v66
  v_dot2c_f32_bf16 v35, v149, v66
  v_dot2c_f32_bf16 v36, v146, v66
  v_dot2c_f32_bf16 v37, v150, v66
  v_dot2c_f32_bf16 v38, v147, v66
  v_dot2c_f32_bf16 v39, v151, v66
  v_dot2c_f32_bf16 v32, v152, v67
  v_dot2c_f32_bf16 v33, v156, v67
  v_dot2c_f32_bf16 v34, v153, v67
  v_dot2c_f32_bf16 v35, v157, v67
  v_dot2c_f32_bf16 v36, v154, v67
  v_dot2c_f32_bf16 v37, v158, v67
  v_dot2c_f32_bf16 v38, v155, v67
  v_dot2c_f32_bf16 v39, v159, v67
  v_dot2c_f32_bf16 v32, v160, v68
  v_dot2c_f32_bf16 v33, v164, v68
  v_dot2c_f32_bf16 v34, v161, v68
  v_dot2c_f32_bf16 v35, v165, v68
  v_dot2c_f32_bf16 v36, v162, v68
  v_dot2c_f32_bf16 v37, v166, v68
  v_dot2c_f32_bf16 v38, v163, v68
  v_dot2c_f32_bf16 v39, v167, v68
  v_dot2c_f32_bf16 v32, v168, v69
  v_dot2c_f32_bf16 v33, v172, v69
  v_dot2c_f32_bf16 v34, v169, v69
  v_dot2c_f32_bf16 v35, v173, v69
  v_dot2c_f32_bf16 v36, v170, v69
  v_dot2c_f32_bf16 v37, v174, v69
  v_dot2c_f32_bf16 v38, v171, v69
  v_dot2c_f32_bf16 v39, v175, v69
  v_dot2c_f32_bf16 v32, v176, v70
  v_dot2c_f32_bf16 v33, v180, v70
  v_dot2c_f32_bf16 v34, v177, v70
  v_dot2c_f32_bf16 v35, v181, v70
  v_dot2c_f32_bf16 v36, v178, v70
  v_dot2c_f32_bf16 v37, v182, v70
  v_dot2c_f32_bf16 v38, v179, v70
  v_dot2c_f32_bf16 v39, v183, v70
  v_dot2c_f32_bf16 v32, v184, v71
  v_dot2c_f32_bf16 v33, v188, v71
  v_dot2c_f32_bf16 v34, v185, v71
  v_dot2c_f32_bf16 v35, v189, v71
  v_dot2c_f32_bf16 v36, v186, v71
  v_dot2c_f32_bf16 v37, v190, v71
  v_dot2c_f32_bf16 v38, v187, v71
  v_dot2c_f32_bf16 v39, v191, v71
  v_dot2c_f32_bf16 v32, v192, v72
  v_dot2c_f32_bf16 v33, v196, v72
  v_dot2c_f32_bf16 v34, v193, v72
  v_dot2c_f32_bf16 v35, v197, v72
  v_dot2c_f32_bf16 v36, v194, v72
  v_dot2c_f32_bf16 v37, v198, v72
  v_dot2c_f32_bf16 v38, v195, v72
  v_dot2c_f32_bf16 v39, v199, v72
  v_dot2c_f32_bf16 v32, v200, v73
  v_dot2c_f32_bf16 v33, v204, v73
  v_dot2c_f32_bf16 v34, v201, v73
  v_dot2c_f32_bf16 v35, v205, v73
  v_dot2c_f32_bf16 v36, v202, v73
  v_dot2c_f32_bf16 v37, v206, v73
  v_dot2c_f32_bf16 v38, v203, v73
  v_dot2c_f32_bf16 v39, v207, v73
  v_dot2c_f32_bf16 v32, v208, v74
  v_dot2c_f32_bf16 v33, v212, v74
  v_dot2c_f32_bf16 v34, v209, v74
  v_dot2c_f32_bf16 v35, v213, v74
  v_dot2c_f32_bf16 v36, v210, v74
  v_dot2c_f32_bf16 v37, v214, v74
  v_dot2c_f32_bf16 v38, v211, v74
  v_dot2c_f32_bf16 v39, v215, v74
  v_dot2c_f32_bf16 v32, v216, v75
  v_dot2c_f32_bf16 v33, v220, v75
  v_dot2c_f32_bf16 v34, v217, v75
  v_dot2c_f32_bf16 v35, v221, v75
  v_dot2c_f32_bf16 v36, v218, v75
  v_dot2c_f32_bf16 v37, v222, v75
  v_dot2c_f32_bf16 v38, v219, v75
  v_dot2c_f32_bf16 v39, v223, v75
  v_dot2c_f32_bf16 v32, v224, v76
  v_dot2c_f32_bf16 v33, v228, v76
  v_dot2c_f32_bf16 v34, v225, v76
  v_dot2c_f32_bf16 v35, v229, v76
  v_dot2c_f32_bf16 v36, v226, v76
  v_dot2c_f32_bf16 v37, v230, v76
  v_dot2c_f32_bf16 v38, v227, v76
  v_dot2c_f32_bf16 v39, v231, v76
  v_dot2c_f32_bf16 v32, v232, v77
  v_dot2c_f32_bf16 v33, v236, v77
  v_dot2c_f32_bf16 v34, v233, v77
  v_dot2c_f32_bf16 v35, v237, v77
  v_dot2c_f32_bf16 v36, v234, v77
  v_dot2c_f32_bf16 v37, v238, v77
  v_dot2c_f32_bf16 v38, v235, v77
  v_dot2c_f32_bf16 v39, v239, v77
  v_dot2c_f32_bf16 v32, v240, v78
  v_dot2c_f32_bf16 v33, v244, v78
  v_dot2c_f32_bf16 v34, v241, v78
  v_dot2c_f32_bf16 v35, v245, v78
  v_dot2c_f32_bf16 v36, v242, v78
  v_dot2c_f32_bf16 v37, v246, v78
  v_dot2c_f32_bf16 v38, v243, v78
  v_dot2c_f32_bf16 v39, v247, v78
  v_dot2c_f32_bf16 v32, v248, v79
  v_dot2c_f32_bf16 v33, v252, v79
  v_dot2c_f32_bf16 v34, v249, v79
  v_dot2c_f32_bf16 v35, v253, v79
  v_dot2c_f32_bf16 v36, v250, v79
  v_dot2c_f32_bf16 v37, v254, v79
  v_dot2c_f32_bf16 v38, v251, v79
  v_dot2c_f32_bf16 v39, v255, v79
  v_permlane32_swap_b32 v32, v36
  v_permlane32_swap_b32 v33, v37
  v_permlane32_swap_b32 v34, v38
  v_permlane32_swap_b32 v35, v39
  v_add_f32 v32, v32, v36
  v_add_f32 v33, v33, v37
  v_add_f32 v34, v34, v38
  v_add_f32 v35, v35, v39
  v_mov_b32 v52, v32
  v_mov_b32 v53, v33
  v_mov_b32 v54, v34
  v_mov_b32 v55, v35
  v_permlane16_swap_b32 v52, v32
  v_permlane16_swap_b32 v53, v33
  v_permlane16_swap_b32 v54, v34
  v_permlane16_swap_b32 v55, v35
  v_add_f32 v32, v32, v52
  v_add_f32 v33, v33, v53
  v_add_f32 v34, v34, v54
  v_add_f32 v35, v35, v55
  v_and_or_b32 v32, v32, s99, v50
  v_and_or_b32 v33, v33, s99, v50
  v_and_or_b32 v34, v34, s99, v50
  v_and_or_b32 v35, v35, s99, v50
  s_mov_b32 exec_lo, 0xffff
  s_mov_b32 exec_hi, 0xffff
  global_store_dwordx4 v48, v[32:35], s[38:39] sc1
  s_mov_b64 exec, -1
  s_cmp_eq_u32 s3, 0
  s_cbranch_scc0 L_tend_39
  s_mov_b32 s52, s16
  s_and_b32 s53, s17, 0xffff
  s_mov_b32 s54, 0x800
  s_mov_b32 s55, 0x20000
  v_and_b32 v52, 7, v0
  v_lshlrev_b32 v52, 2, v52
  v_lshrrev_b32 v53, 4, v0
  v_add_u32 v52, v52, v53
  s_lshl_b32 s4, s44, 5
  v_add_u32 v53, s4, v52
  v_lshlrev_b32 v53, 1, v53
  buffer_load_ushort v54, v53, s[52:55], 0 offen
  s_lshl_b32 s5, s44, 7
  s_add_u32 s4, s5, 1376256
  v_lshrrev_b32 v20, 3, v0
  s_mov_b32 s5, 4224
  v_mul_lo_u32 v20, v20, s5
  v_and_b32 v21, 7, v0
  v_lshl_add_u32 v20, v21, 4, v20
  v_add_u32 v20, s4, v20
  v_add_u32 v9, 33792, v20
  v_add_u32 v10, 67584, v20
  v_add_u32 v11, 101376, v20
  s_lshr_b32 s4, s44, 3
  s_mul_i32 s4, s4, 1152
  s_and_b32 s5, s44, 7
  s_lshl_b32 s5, s5, 7
  s_add_u32 s4, s4, s5
  s_add_u32 s4, s4, 2686976
  v_lshrrev_b32 v24, 3, v0
  s_mov_b32 s5, 4608
  v_mul_lo_u32 v24, v24, s5
  v_and_b32 v21, 7, v0
  v_lshl_add_u32 v24, v21, 4, v24
  v_add_u32 v24, s4, v24
  v_add_u32 v25, 36864, v24
  v_add_u32 v26, 73728, v24
  v_add_u32 v27, 110592, v24
  v_add_u32 v28, 147456, v24
  v_add_u32 v29, 184320, v24
  v_add_u32 v30, 221184, v24
  s_lshl_b32 s4, s44, 7
  s_add_u32 s4, s4, 2523136
  v_and_b32 v31, 7, v0
  v_lshlrev_b32 v31, 4, v31
  v_lshrrev_b32 v23, 3, v0
  v_lshl_add_u32 v31, v23, 12, v31
  v_add_u32 v31, s4, v31
  v_mov_b32 v22, s46
  s_mov_b32 s6, 0xfff
  s_mov_b32 s96, 0
L_mp_40:
  global_load_dwordx4 v[64:67], v20, s[38:39] sc1
  global_load_dwordx4 v[68:71], v9, s[38:39] sc1
  global_load_dwordx4 v[72:75], v10, s[38:39] sc1
  global_load_dwordx4 v[76:79], v11, s[38:39] sc1
  s_waitcnt vmcnt(0)
  v_xor_b32 v64, v22, v64
  v_xor_b32 v65, v22, v65
  v_xor_b32 v66, v22, v66
  v_xor_b32 v67, v22, v67
  v_xor_b32 v68, v22, v68
  v_xor_b32 v69, v22, v69
  v_xor_b32 v70, v22, v70
  v_xor_b32 v71, v22, v71
  v_xor_b32 v72, v22, v72
  v_xor_b32 v73, v22, v73
  v_xor_b32 v74, v22, v74
  v_xor_b32 v75, v22, v75
  v_xor_b32 v76, v22, v76
  v_xor_b32 v77, v22, v77
  v_xor_b32 v78, v22, v78
  v_xor_b32 v79, v22, v79
  v_or_b32 v23, v64, v65
  v_or3_b32 v23, v23, v66, v67
  v_or3_b32 v23, v23, v68, v69
  v_or3_b32 v23, v23, v70, v71
  v_or3_b32 v23, v23, v72, v73
  v_or3_b32 v23, v23, v74, v75
  v_or3_b32 v23, v23, v76, v77
  v_or3_b32 v23, v23, v78, v79
  v_and_b32 v23, s6, v23
  v_cmp_ne_u32 vcc, 0, v23
  s_and_b64 exec, exec, vcc
  s_cbranch_execz L_mok_41
  s_add_u32 s96, s96, 1
  s_cmp_lt_u32 s96, 400000
  s_cbranch_scc1 L_mp_40
  s_branch L_abort
L_mok_41:
  s_mov_b64 exec, -1
  v_add_f32 v64, v64, v68
  v_add_f32 v72, v72, v76
  v_add_f32 v65, v65, v69
  v_add_f32 v73, v73, v77
  v_add_f32 v66, v66, v70
  v_add_f32 v74, v74, v78
  v_add_f32 v67, v67, v71
  v_add_f32 v75, v75, v79
  v_add_f32 v64, v64, v72
  v_add_f32 v65, v65, v73
  v_add_f32 v66, v66, v74
  v_add_f32 v67, v67, v75
  s_nop 0
  v_permlane32_swap_b32 v64, v66
  v_permlane32_swap_b32 v65, v67
  v_add_f32 v64, v64, v66
  v_add_f32 v65, v65, v67
  s_nop 1
  v_permlane16_swap_b32 v64, v65
  v_add_f32 v64, v64, v65
  s_nop 1
  v_add_f32_dpp v64, v64, v64 row_ror:8 row_mask:0xf bank_mask:0xf
  v_lshlrev_b32 v54, 16, v54
  v_cvt_pk_bf16_f32 v64, v64, v64
  v_and_b32 v64, s97, v64
  v_add_f32 v64, v54, v64
  v_cvt_pk_bf16_f32 v51, v64, v64
  v_and_b32 v51, s97, v51
  v_or_b32 v33, s47, v51
  v_mov_b32 v36, v33
  v_mov_b32 v37, v33
  s_nop 1
  v_permlane16_swap_b32 v36, v37
  v_mov_b32 v38, v36
  v_mov_b32 v39, v37
  s_nop 0
  v_permlane32_swap_b32 v36, v38
  v_permlane32_swap_b32 v37, v39
  global_store_dwordx4 v31, v[36:39], s[38:39] sc1
  s_mov_b32 s96, 0
L_mp_42:
  global_load_dwordx4 v[64:67], v24, s[38:39] sc1
  global_load_dwordx4 v[68:71], v25, s[38:39] sc1
  global_load_dwordx4 v[72:75], v26, s[38:39] sc1
  global_load_dwordx4 v[76:79], v27, s[38:39] sc1
  global_load_dwordx4 v[80:83], v28, s[38:39] sc1
  global_load_dwordx4 v[84:87], v29, s[38:39] sc1
  global_load_dwordx4 v[88:91], v30, s[38:39] sc1
  s_waitcnt vmcnt(0)
  v_xor_b32 v64, v22, v64
  v_xor_b32 v65, v22, v65
  v_xor_b32 v66, v22, v66
  v_xor_b32 v67, v22, v67
  v_xor_b32 v68, v22, v68
  v_xor_b32 v69, v22, v69
  v_xor_b32 v70, v22, v70
  v_xor_b32 v71, v22, v71
  v_xor_b32 v72, v22, v72
  v_xor_b32 v73, v22, v73
  v_xor_b32 v74, v22, v74
  v_xor_b32 v75, v22, v75
  v_xor_b32 v76, v22, v76
  v_xor_b32 v77, v22, v77
  v_xor_b32 v78, v22, v78
  v_xor_b32 v79, v22, v79
  v_xor_b32 v80, v22, v80
  v_xor_b32 v81, v22, v81
  v_xor_b32 v82, v22, v82
  v_xor_b32 v83, v22, v83
  v_xor_b32 v84, v22, v84
  v_xor_b32 v85, v22, v85
  v_xor_b32 v86, v22, v86
  v_xor_b32 v87, v22, v87
  v_xor_b32 v88, v22, v88
  v_xor_b32 v89, v22, v89
  v_xor_b32 v90, v22, v90
  v_xor_b32 v91, v22, v91
  v_or_b32 v23, v64, v65
  v_or3_b32 v23, v23, v66, v67
  v_or3_b32 v23, v23, v68, v69
  v_or3_b32 v23, v23, v70, v71
  v_or3_b32 v23, v23, v72, v73
  v_or3_b32 v23, v23, v74, v75
  v_or3_b32 v23, v23, v76, v77
  v_or3_b32 v23, v23, v78, v79
  v_or3_b32 v23, v23, v80, v81
  v_or3_b32 v23, v23, v82, v83
  v_or3_b32 v23, v23, v84, v85
  v_or3_b32 v23, v23, v86, v87
  v_or3_b32 v23, v23, v88, v89
  v_or3_b32 v23, v23, v90, v91
  v_and_b32 v23, s6, v23
  v_cmp_ne_u32 vcc, 0, v23
  s_and_b64 exec, exec, vcc
  s_cbranch_execz L_mok_43
  s_add_u32 s96, s96, 1
  s_cmp_lt_u32 s96, 400000
  s_cbranch_scc1 L_mp_42
  s_branch L_abort
L_mok_43:
  s_mov_b64 exec, -1
  v_add_f32 v64, v64, v68
  v_add_f32 v72, v72, v76
  v_add_f32 v80, v80, v84
  v_add_f32 v65, v65, v69
  v_add_f32 v73, v73, v77
  v_add_f32 v81, v81, v85
  v_add_f32 v66, v66, v70
  v_add_f32 v74, v74, v78
  v_add_f32 v82, v82, v86
  v_add_f32 v67, v67, v71
  v_add_f32 v75, v75, v79
  v_add_f32 v83, v83, v87
  v_add_f32 v64, v64, v72
  v_add_f32 v80, v80, v88
  v_add_f32 v65, v65, v73
  v_add_f32 v81, v81, v89
  v_add_f32 v66, v66, v74
  v_add_f32 v82, v82, v90
  v_add_f32 v67, v67, v75
  v_add_f32 v83, v83, v91
  v_add_f32 v64, v64, v80
  v_add_f32 v65, v65, v81
  v_add_f32 v66, v66, v82
  v_add_f32 v67, v67, v83
  s_nop 0
  v_permlane32_swap_b32 v64, v66
  v_permlane32_swap_b32 v65, v67
  v_add_f32 v64, v64, v66
  v_add_f32 v65, v65, v67
  s_nop 1
  v_permlane16_swap_b32 v64, v65
  v_add_f32 v64, v64, v65
  s_nop 1
  v_add_f32_dpp v64, v64, v64 row_ror:8 row_mask:0xf bank_mask:0xf
  v_cvt_pk_bf16_f32 v64, v64, v64
  v_and_b32 v64, s97, v64
  v_add_f32 v64, v51, v64
  v_cvt_pk_bf16_f32 v64, v64, v64
  s_lshl_b32 s4, s44, 6
  v_lshlrev_b32 v20, 1, v52
  v_add_u32 v20, s4, v20
  s_mov_b32 exec_lo, 0x00ff00ff
  s_mov_b32 exec_hi, 0x00ff00ff
  global_store_short v20, v64, s[34:35]
  s_cmp_eq_u32 s44, 0
  s_cbranch_scc0 L_noe_44
  s_mov_b64 exec, 1
  v_mov_b32 v20, 0
  v_mov_b32 v21, s40
  global_store_dword v20, v21, s[38:39]
L_noe_44:
  s_mov_b64 exec, -1
L_tend_39:
  s_endpgm
L_abort:
  s_endpgm
L_exit:
  s_endpgm
L_codeend:
.section .rodata,"a"
.p2align 6
.amdhsa_kernel sequential_preLN__gqa_block_cached__geglu_ffn__decode_kernel
  .amdhsa_next_free_vgpr 256
  .amdhsa_next_free_sgpr 102
  .amdhsa_accum_offset 256
  .amdhsa_group_segment_fixed_size 0
  .amdhsa_kernarg_size 96
  .amdhsa_user_sgpr_count 2
  .amdhsa_user_sgpr_kernarg_segment_ptr 1
  .amdhsa_system_sgpr_workgroup_id_x 1
.end_amdhsa_kernel
```
